```python
import torch

def _softmax(x, axis=-1):
    return torch.softmax(x, dim=axis)

def _gelu(x):
    return torch.nn.functional.gelu(x, approximate='tanh')

def _silu(x):
    return torch.nn.functional.silu(x)

def _sigmoid(x):
    return torch.sigmoid(x)

def _layernorm(x, axis=-1, eps=1e-05):
    m = x.mean(dim=axis, keepdim=True)
    v = x.var(dim=axis, keepdim=True, unbiased=False)
    return (x - m) / torch.sqrt(v + eps)

def _scatter_add(tgt, idx, src, axis=0):
    return tgt.clone().index_add_(axis, idx, src)

def _segment_sum(src, seg, n):
    out = torch.zeros((n,) + src.shape[1:], dtype=src.dtype)
    return out.index_add_(0, seg, src)

def _pad(x, pw):
    flat = tuple((v for pair in reversed(pw) for v in pair))
    return torch.nn.functional.pad(x, flat)
kernel_name = 'adaLN_cond__compressed_kv_cla__swiglu_ffn__decode'

def setup_inputs():

    _w = lambda a: (lambda t: t.to(torch.bfloat16) if t.is_floating_point() else t)(torch.as_tensor(a))

    def _A_setup():
        B, H, Sq, Sk, D, M = (2, 32, 1, 8192, 128, 640)
        Dc = 4 * D
        return {'x': _w((lambda *s: torch.randn(*s, dtype=torch.bfloat16) * 0.05)(B, Sq, M)), 'c_kv': _w((lambda *s: torch.randn(*s, dtype=torch.bfloat16) * 1.6)(B, Sk, Dc)), 'w_q': _w((lambda *s: torch.randn(*s, dtype=torch.bfloat16) * 1.6)(M, H, D) * M ** (-0.5)), 'w_uk': _w((lambda *s: torch.randn(*s, dtype=torch.bfloat16) * 1.6)(Dc, H, D) * Dc ** (-0.5)), 'w_uv': _w((lambda *s: torch.randn(*s, dtype=torch.bfloat16) * 1.6)(Dc, H, D) * Dc ** (-0.5)), 'w_o': _w((lambda *s: torch.randn(*s, dtype=torch.bfloat16) * 1.6)(H, D, M) * (H * D) ** (-0.5))}
    _A_in = _A_setup()

    def _B_setup():
        B, S, D, F = (2, 1, 640, 1728)
        return {'x': _w((lambda *s: torch.randn(*s, dtype=torch.bfloat16) * 0.05)(B, S, D)), 'w_gate': _w((lambda *s: torch.randn(*s, dtype=torch.bfloat16) * 0.05)(D, F)), 'w_up': _w((lambda *s: torch.randn(*s, dtype=torch.bfloat16) * 0.05)(D, F)), 'w_down': _w((lambda *s: torch.randn(*s, dtype=torch.bfloat16) * 0.05)(F, D))}
    _B_in = _B_setup()
    return {'A_x': _A_in['x'], 'A_c_kv': _A_in['c_kv'], 'A_w_q': _A_in['w_q'], 'A_w_uk': _A_in['w_uk'], 'A_w_uv': _A_in['w_uv'], 'A_w_o': _A_in['w_o'], 'B_x': _B_in['x'], 'B_w_gate': _B_in['w_gate'], 'B_w_up': _B_in['w_up'], 'B_w_down': _B_in['w_down'], 'c': _w((lambda *s: torch.randn(*s, dtype=torch.bfloat16) * 0.2)(2, 640) * 8.0), 'w_mod': _w((lambda *s: torch.randn(*s, dtype=torch.bfloat16) * 0.2)(640, 6 * 640) * 640 ** (-0.5) * 8.0)}

def reference(A_x, A_c_kv, A_w_q, A_w_uk, A_w_uv, A_w_o, B_x, B_w_gate, B_w_up, B_w_down, c, w_mod):

    def _A_ref(x, c_kv, w_q, w_uk, w_uv, w_o):
        B, Sq, M = (x.shape[0], x.shape[1], x.shape[2])
        Sk = c_kv.shape[1]
        H, D = (w_q.shape[1], w_q.shape[2])
        q = torch.einsum('bqm,mhd->bhqd', x, w_q)
        k = torch.einsum('bkc,chd->bhkd', c_kv, w_uk)
        v = torch.einsum('bkc,chd->bhkd', c_kv, w_uv)
        scores = torch.einsum('bhqd,bhkd->bhqk', q, k) * D ** (-0.5)
        off = Sk - Sq
        qi = torch.arange(Sq)[:, None]
        kj = torch.arange(Sk)[None, :]
        cmask = kj <= qi + off
        scores = torch.where(cmask[None, None], scores, -1000000000.0)
        p = _softmax(scores, axis=-1)
        ctx = torch.einsum('bhqk,bhkd->bhqd', p, v)
        return torch.einsum('bhqd,hdm->bqm', ctx, w_o)

    def _B_ref(x, w_gate, w_up, w_down):
        g = _silu(x @ w_gate)
        u = x @ w_up
        return g * u @ w_down
    x = A_x
    mod = (_silu(c) @ w_mod).reshape(c.shape[0], 6, 1, -1)
    sa, ca, ga, sb, cb, gb = (mod[:, 0].clone(), mod[:, 1].clone(), mod[:, 2].clone(), mod[:, 3].clone(), mod[:, 4].clone(), mod[:, 5].clone())
    h = _layernorm(x, axis=-1) * (1 + ca) + sa
    x = x + ga * _A_ref(h, A_c_kv, A_w_q, A_w_uk, A_w_uv, A_w_o)
    h = _layernorm(x, axis=-1) * (1 + cb) + sb
    x = x + gb * _B_ref(h, B_w_gate, B_w_up, B_w_down)
    return x
```

```asm
; @launch grid=(256,1,1) block=(512,1,1) lds=163840
.amdgcn_target "amdgcn-amd-amdhsa--gfx950"
.text
.globl adaLN_cond__compressed_kv_cla__swiglu_ffn__decode_kernel
.p2align 8
.type adaLN_cond__compressed_kv_cla__swiglu_ffn__decode_kernel,@function
adaLN_cond__compressed_kv_cla__swiglu_ffn__decode_kernel:
    s_cmp_ge_u32 s2, 256
    s_cbranch_scc1 L_END
    s_load_dwordx16 s[16:31], s[0:1], 0
    s_load_dwordx8 s[32:39], s[0:1], 64
    s_load_dwordx4 s[40:43], s[0:1], 96
    s_load_dwordx2 s[44:45], s[0:1], 112
    v_and_b32 v1, 63, v0
    v_lshrrev_b32 v12, 6, v0
    v_and_b32 v2, 15, v0
    v_bfe_u32 v3, v0, 4, 2
    v_readfirstlane_b32 s3, v12
    v_lshlrev_b32 v8, 4, v1
    v_bfe_u32 v10, v0, 3, 1
    v_bfe_u32 v11, v0, 5, 1
    v_and_b32 v12, 16, v0
    v_lshl_add_u32 v9, v2, 5, v12
    v_and_b32 v12, 1, v0
    v_lshlrev_b32 v12, 4, v12
    v_mov_b32 v13, 0xffff
    v_lshlrev_b32 v13, v12, v13
    v_bfe_u32 v12, v0, 1, 2
    v_cmp_eq_u32 vcc, 0, v12
    s_nop 1
    v_cndmask_b32 v4, 0, v13, vcc
    v_cmp_eq_u32 vcc, 1, v12
    s_nop 1
    v_cndmask_b32 v5, 0, v13, vcc
    v_cmp_eq_u32 vcc, 2, v12
    s_nop 1
    v_cndmask_b32 v6, 0, v13, vcc
    v_cmp_eq_u32 vcc, 3, v12
    s_nop 1
    v_cndmask_b32 v7, 0, v13, vcc
    v_mov_b32 v14, 0
    v_mov_b32 v15, 0
    s_lshr_b32 s15, s2, 4
    s_and_b32 s14, s2, 7
    s_lshl_b32 s7, s15, 3
    s_add_u32 s4, s7, s14
    s_bitcmp1_b32 s2, 3
    s_cbranch_scc1 L_WCU
    s_mov_b32 s7, 0x1999999a
    s_mul_hi_u32 s9, s4, s7
    s_mul_i32 s10, s9, 10
    s_sub_u32 s10, s4, s10
    s_lshr_b32 s7, s3, 1
    s_lshl_b32 s7, s7, 4
    s_and_b32 s8, s3, 1
    s_lshl_b32 s8, s8, 1
    s_add_u32 s7, s7, s8
    s_lshl_b32 s8, s9, 6
    s_add_u32 s7, s7, s8
    v_lshl_add_u32 v12, v3, 2, s7
    v_mul_u32_u24 v13, 1280, v10
    v_lshl_add_u32 v14, v12, 1, v13
    v_mul_u32_u24 v12, 7680, v12
    v_add_u32 v12, v12, v13
    v_and_b32 v13, 7, v0
    v_lshl_add_u32 v12, v13, 4, v12
    s_and_b32 s7, s3, 2
    s_lshl_b32 s7, s7, 2
    s_or_b32 s8, s7, 0
    v_xor_b32 v240, s8, v1
    v_lshlrev_b32 v240, 4, v240
    s_or_b32 s8, s7, 2
    v_xor_b32 v241, s8, v1
    v_lshlrev_b32 v241, 4, v241
    s_or_b32 s8, s7, 4
    v_xor_b32 v242, s8, v1
    v_lshlrev_b32 v242, 4, v242
    s_or_b32 s8, s7, 6
    v_xor_b32 v243, s8, v1
    v_lshlrev_b32 v243, 4, v243
    v_mov_b32 v172, -1
    v_mov_b32 v173, -1
    v_mov_b32 v174, -1
    v_mov_b32 v175, -1
    s_lshl_b32 s7, s10, 7
    s_waitcnt lgkmcnt(0)
    s_load_dword s5, s[44:45], 0
    s_mov_b32 s48, s44
    s_and_b32 s49, s45, 0xffff
    s_mov_b32 s50, 0x10000000
    s_mov_b32 s51, 0x20000
    s_mov_b32 s52, s36
    s_and_b32 s53, s37, 0xffff
    s_mov_b32 s54, 0xa00
    s_mov_b32 s55, 0x20000
    s_mov_b32 s56, s38
    s_and_b32 s57, s39, 0xffff
    s_mov_b32 s58, 0x4b0000
    s_mov_b32 s59, 0x20000
    s_cmp_ge_u32 s4, 100
    s_cbranch_scc1 L_A_NOM1
    buffer_load_dword v144, v14, s[52:55], 0 offen
    buffer_load_dwordx4 v[152:155], v12, s[56:59], s7 offen nt
    s_add_u32 s7, s7, 7680
    buffer_load_dwordx4 v[156:159], v12, s[56:59], s7 offen nt
    s_lshl_b32 s7, s4, 11
    s_lshl_b32 s8, s3, 8
    s_add_u32 s7, s7, s8
    s_add_u32 s7, s7, 524288
    s_mov_b64 exec, 0xffff
    buffer_store_dwordx4 v[172:175], v8, s[48:51], s7 offen sc1
    s_mov_b64 exec, -1
    s_nop 0
L_A_NOM1:
    s_cmp_lg_u32 s15, 15
    s_cbranch_scc1 NOCPF_1
    s_cmp_ge_u32 s3, 4
    s_cbranch_scc1 NOCPF_1
    s_getpc_b64 s[12:13]
L_PCREF:
    s_sub_u32 s12, s12, L_PCREF-adaLN_cond__compressed_kv_cla__swiglu_ffn__decode_kernel
    s_subb_u32 s13, s13, 0
    v_lshlrev_b32 v13, 7, v0
    v_min_u32 v13, L_CODE_END-adaLN_cond__compressed_kv_cla__swiglu_ffn__decode_kernel-4, v13
    global_load_dword v149, v13, s[12:13]
    s_nop 0
NOCPF_1:
    s_mov_b32 s60, s18
    s_and_b32 s61, s19, 0xffff
    s_mov_b32 s62, 0x1000000
    s_mov_b32 s63, 0x20000
    s_mov_b32 s64, s26
    s_and_b32 s65, s27, 0xffff
    s_mov_b32 s66, 0x500000
    s_mov_b32 s67, 0x20000
    s_cmp_ge_u32 s15, 10
    s_cselect_b32 s66, 0, s66
    s_mov_b32 s68, s40
    s_and_b32 s69, s41, 0xffff
    s_mov_b32 s70, 0xa00
    s_mov_b32 s71, 0x20000
    s_mov_b32 s72, s22
    s_and_b32 s73, s23, 0xffff
    s_mov_b32 s74, 0x400000
    s_mov_b32 s75, 0x20000
    s_lshl_b32 s17, s3, 12
    s_lshr_b32 s7, s14, 2
    s_lshl_b32 s7, s7, 6
    s_and_b32 s8, s14, 3
    s_add_u32 s7, s7, s8
    s_lshl_b32 s8, s15, 2
    s_add_u32 s7, s7, s8
    s_lshl_b32 s16, s7, 17
    s_add_u32 s16, s16, s17
    s_waitcnt lgkmcnt(0)
    s_add_u32 s5, s5, 1
    s_mov_b32 s40, 0x7060302
    s_mov_b32 s41, 0xc0c0501
    s_mov_b32 s42, 0x5010c0c
    s_mov_b32 s43, 0x504000c
    s_mov_b32 s44, 0x706010c
    s_mov_b32 s45, 0x504020c
    s_mov_b32 s46, 0x706030c
    s_cmp_ge_u32 s4, 100
    s_cbranch_scc1 L_A_NOM2
    s_lshl_b32 s7, s3, 10
    s_add_u32 s7, s7, 131072
    v_add_u32 v12, s7, v8
    v_lshl_add_u32 v13, v10, 1, v11
    v_mul_u32_u24 v13, 2560, v13
    v_and_b32 v14, 0xff, v9
    v_add_u32 v13, v13, v14
    s_mul_i32 s7, s9, 10240
    s_lshl_b32 s8, s10, 8
    s_add_u32 s7, s7, s8
    s_add_u32 s11, s7, 40960
    s_cmp_lg_u32 s3, 0
    s_cbranch_scc1 SKIP_2
    s_sub_u32 s7, s5, 1
    v_mov_b32 v56, s7
    v_mov_b32 v57, s7
    v_mov_b32 v58, s7
    v_mov_b32 v59, s7
    buffer_store_dwordx4 v[56:59], v13, s[48:51], s11 offen sc1
    s_nop 1
SKIP_2:
    s_cmp_eq_u32 s3, 0
    s_cbranch_scc1 SKIP_3
    s_waitcnt vmcnt(3)
SKIP_3:
    s_waitcnt vmcnt(4)
    v_lshlrev_b32 v145, 16, v144
    v_and_b32 v146, 0xffff0000, v144
    v_mul_f32 v147, 0x3fb8aa3b, v145
    v_mul_f32 v148, 0x3fb8aa3b, v146
    v_exp_f32 v147, -v147
    v_exp_f32 v148, -v148
    v_add_f32 v147, 1.0, v147
    v_add_f32 v148, 1.0, v148
    v_rcp_f32 v147, v147
    v_rcp_f32 v148, v148
    v_mul_f32 v145, v145, v147
    v_mul_f32 v146, v146, v148
    v_cvt_pk_bf16_f32 v145, v145, v145
    v_cvt_pk_bf16_f32 v146, v146, v146
    v_and_b32 v160, v145, v4
    v_and_b32 v161, v145, v5
    v_and_b32 v162, v145, v6
    v_and_b32 v163, v145, v7
    v_and_b32 v164, v146, v4
    v_and_b32 v165, v146, v5
    v_and_b32 v166, v146, v6
    v_and_b32 v167, v146, v7
    s_cmp_eq_u32 s3, 0
    s_nop 0
    s_cbranch_scc1 SKIP_4
    s_waitcnt vmcnt(1)
SKIP_4:
    s_waitcnt vmcnt(2)
    v_mfma_f32_16x16x32_bf16 v[168:171], v[160:163], v[152:155], 0
    v_mfma_f32_16x16x32_bf16 v[168:171], v[164:167], v[156:159], v[168:171]
    s_nop 7
    ds_write_b128 v12, v[168:171]
    s_waitcnt lgkmcnt(0)
    s_barrier
    s_cmp_lg_u32 s3, 0
    s_cbranch_scc1 SKIP_5
    ds_read_b128 v[16:19], v12 offset:0
    ds_read_b128 v[20:23], v12 offset:1024
    ds_read_b128 v[24:27], v12 offset:2048
    ds_read_b128 v[28:31], v12 offset:3072
    ds_read_b128 v[32:35], v12 offset:4096
    ds_read_b128 v[36:39], v12 offset:5120
    ds_read_b128 v[40:43], v12 offset:6144
    ds_read_b128 v[44:47], v12 offset:7168
    s_waitcnt lgkmcnt(6)
    v_pk_add_f32 v[16:17], v[16:17], v[20:21]
    v_pk_add_f32 v[18:19], v[18:19], v[22:23]
    s_waitcnt lgkmcnt(4)
    v_pk_add_f32 v[24:25], v[24:25], v[28:29]
    v_pk_add_f32 v[26:27], v[26:27], v[30:31]
    s_waitcnt lgkmcnt(2)
    v_pk_add_f32 v[32:33], v[32:33], v[36:37]
    v_pk_add_f32 v[34:35], v[34:35], v[38:39]
    s_waitcnt lgkmcnt(0)
    v_pk_add_f32 v[40:41], v[40:41], v[44:45]
    v_pk_add_f32 v[42:43], v[42:43], v[46:47]
    v_pk_add_f32 v[16:17], v[16:17], v[24:25]
    v_pk_add_f32 v[18:19], v[18:19], v[26:27]
    v_pk_add_f32 v[32:33], v[32:33], v[40:41]
    v_pk_add_f32 v[34:35], v[34:35], v[42:43]
    v_pk_add_f32 v[16:17], v[16:17], v[32:33]
    v_pk_add_f32 v[18:19], v[18:19], v[34:35]
    v_perm_b32 v144, v17, v16, s40
    v_perm_b32 v145, v19, v18, s40
    v_perm_b32 v147, v17, v16, s41
    v_perm_b32 v148, v19, v18, s42
    v_mov_b32 v146, s5
    v_or_b32 v147, v147, v148
    buffer_store_dwordx4 v[144:147], v13, s[48:51], s11 offen sc1
    s_lshl_b32 s7, s4, 7
    s_add_u32 s7, s7, 196608
    s_mov_b64 exec, 1
    buffer_store_dword v146, v15, s[48:51], s7 offen sc1
    s_mov_b64 exec, -1
SKIP_5:
    s_cmp_eq_u32 s3, 0
    s_cbranch_scc1 SKIP_6
    s_waitcnt vmcnt(0)
SKIP_6:
    s_waitcnt vmcnt(2)
    s_barrier
    s_cmp_lg_u32 s3, 5
    s_cbranch_scc1 SKIP_7
    v_mov_b32 v202, s5
    s_lshl_b32 s10, s4, 7
    s_add_u32 s10, s10, 180224
    s_mov_b64 exec, 1
    buffer_store_dword v202, v15, s[48:51], s10 offen sc1
    s_mov_b64 exec, -1
SKIP_7:
L_A_NOM2:
    s_add_u32 m0, s17, 0
    s_add_u32 s8, s16, 0
    buffer_load_dwordx4 v240, s[60:63], s8 offen nt lds
    s_add_u32 m0, s17, 1024
    s_add_u32 s8, s16, 1024
    buffer_load_dwordx4 v241, s[60:63], s8 offen nt lds
    s_add_u32 m0, s17, 2048
    s_add_u32 s8, s16, 2048
    buffer_load_dwordx4 v242, s[60:63], s8 offen nt lds
    s_add_u32 m0, s17, 3072
    s_add_u32 s8, s16, 3072
    buffer_load_dwordx4 v243, s[60:63], s8 offen nt lds
    s_cmp_lg_u32 s3, 7
    s_cbranch_scc1 SKIP_8
    s_getreg_b32 s7, hwreg(HW_REG_XCC_ID)
    s_and_b32 s7, s7, 0xf
    v_mov_b32 v220, s7
    v_mov_b32 v221, s5
    s_lshl_b32 s7, s14, 4
    s_add_u32 s7, s7, s15
    s_lshl_b32 s7, s7, 7
    s_add_u32 s7, s7, 4096
    s_mov_b64 exec, 1
    buffer_store_dwordx2 v[220:221], v15, s[48:51], s7 offen sc1
    s_mov_b64 exec, -1
SKIP_8:
    v_and_b32 v12, 3, v0
    v_lshlrev_b32 v12, 1, v12
    v_and_b32 v13, 8, v0
    v_or_b32 v12, v12, v13
    s_lshl_b32 s7, s3, 14
    s_and_b32 s12, s3, 0
    s_lshl_b32 s12, s12, 9
    s_add_u32 s7, s7, s12
    s_add_u32 s12, s12, 131072
    v_add_u32 v13, 0, v3
    v_xor_b32 v13, v13, v12
    v_lshlrev_b32 v13, 4, v13
    v_lshl_add_u32 v224, v2, 10, v13
    v_lshl_add_u32 v228, v2, 8, v13
    v_add_u32 v232, s7, v224
    v_xor_b32 v216, 0x4000, v232
    v_add_u32 v224, s12, v224
    v_add_u32 v13, 4, v3
    v_xor_b32 v13, v13, v12
    v_lshlrev_b32 v13, 4, v13
    v_lshl_add_u32 v225, v2, 10, v13
    v_lshl_add_u32 v229, v2, 8, v13
    v_add_u32 v233, s7, v225
    v_xor_b32 v217, 0x4000, v233
    v_add_u32 v225, s12, v225
    v_add_u32 v13, 8, v3
    v_xor_b32 v13, v13, v12
    v_lshlrev_b32 v13, 4, v13
    v_lshl_add_u32 v226, v2, 10, v13
    v_lshl_add_u32 v230, v2, 8, v13
    v_add_u32 v234, s7, v226
    v_xor_b32 v218, 0x4000, v234
    v_add_u32 v226, s12, v226
    v_add_u32 v13, 12, v3
    v_xor_b32 v13, v13, v12
    v_lshlrev_b32 v13, 4, v13
    v_lshl_add_u32 v227, v2, 10, v13
    v_lshl_add_u32 v231, v2, 8, v13
    v_add_u32 v235, s7, v227
    v_xor_b32 v219, 0x4000, v235
    v_add_u32 v227, s12, v227
    v_bfe_u32 v14, v0, 2, 2
    v_bfe_u32 v13, v0, 4, 1
    v_lshlrev_b32 v13, 3, v13
    v_lshl_or_b32 v13, v14, 1, v13
    v_lshl_add_u32 v14, v3, 3, v14
    v_lshlrev_b32 v14, 10, v14
    v_and_b32 v15, 3, v0
    s_lshl_b32 s7, s3, 3
    v_add_u32 v15, s7, v15
    v_add_u32 v236, 0, v15
    v_xor_b32 v236, v236, v13
    v_lshl_add_u32 v236, v236, 4, v14
    v_add_u32 v238, 0x10000, v236
    v_add_u32 v237, 4, v15
    v_xor_b32 v237, v237, v13
    v_lshl_add_u32 v237, v237, 4, v14
    v_add_u32 v239, 0x10000, v237
    s_waitcnt vmcnt(3)
    s_add_u32 m0, s17, 32768
    s_add_u32 s8, s16, 32768
    buffer_load_dwordx4 v240, s[60:63], s8 offen nt lds
    s_lshl_b32 s7, s3, 1
    v_add_u32 v13, s7, v11
    v_xor_b32 v13, v13, v12
    v_lshlrev_b32 v13, 4, v13
    v_lshl_add_u32 v13, v2, 8, v13
    v_bfe_u32 v14, v0, 4, 1
    v_lshl_add_u32 v252, v14, 3, v13
    v_lshl_add_u32 v253, v11, 4, v2
    v_lshlrev_b32 v253, 5, v253
    s_lshl_b32 s7, s3, 2
    v_add_u32 v254, s7, v253
    s_add_u32 s18, s17, 131072
    v_add_u32 v255, s18, v8
    v_mul_u32_u24 v192, 5120, v3
    v_lshl_add_u32 v192, v2, 4, v192
    v_lshlrev_b32 v193, 2, v253
    v_mul_u32_u24 v194, 4096, v3
    v_lshl_add_u32 v194, v2, 4, v194
    v_lshlrev_b32 v195, 5, v3
    v_lshlrev_b32 v196, 18, v10
    v_lshl_add_u32 v196, v3, 4, v196
    v_and_b32 v13, 3, v0
    v_lshl_add_u32 v196, v13, 11, v196
    s_lshl_b32 s7, s3, 10
    s_waitcnt vmcnt(3)
    s_add_u32 m0, s17, 33792
    s_add_u32 s8, s16, 33792
    buffer_load_dwordx4 v241, s[60:63], s8 offen nt lds
    v_add_u32 v197, s7, v8
    v_lshl_add_u32 v198, v11, 9, v9
    v_and_b32 v199, 7, v0
    v_mul_u32_u24 v199, 16384, v199
    v_lshl_add_u32 v199, v3, 4, v199
    v_lshl_add_u32 v199, v10, 6, v199
    s_lshl_b32 s7, s3, 11
    v_add_u32 v200, s7, v8
    v_xor_b32 v201, 0x800, v200
    s_lshl_b32 s7, s3, 3
    v_add_u32 v13, s7, v3
    v_add_u32 v14, 0, v13
    v_xor_b32 v14, v14, v2
    v_lshlrev_b32 v14, 4, v14
    v_lshl_add_u32 v176, v2, 10, v14
    v_add_u32 v14, 4, v13
    v_xor_b32 v14, v14, v2
    v_lshlrev_b32 v14, 4, v14
    v_lshl_add_u32 v177, v2, 10, v14
    s_lshl_b32 s7, s3, 2
    s_add_u32 s12, s7, 0
    s_and_b32 s13, s12, 15
    v_xor_b32 v13, s13, v1
    s_lshl_b32 s12, s12, 10
    s_waitcnt vmcnt(3)
    s_add_u32 m0, s17, 34816
    s_add_u32 s8, s16, 34816
    buffer_load_dwordx4 v242, s[60:63], s8 offen nt lds
    v_lshl_add_u32 v180, v13, 4, s12
    s_add_u32 s12, s7, 1
    s_and_b32 s13, s12, 15
    v_xor_b32 v13, s13, v1
    s_lshl_b32 s12, s12, 10
    v_lshl_add_u32 v181, v13, 4, s12
    s_add_u32 s12, s7, 2
    s_and_b32 s13, s12, 15
    v_xor_b32 v13, s13, v1
    s_lshl_b32 s12, s12, 10
    v_lshl_add_u32 v182, v13, 4, s12
    s_add_u32 s12, s7, 3
    s_and_b32 s13, s12, 15
    v_xor_b32 v13, s13, v1
    s_lshl_b32 s12, s12, 10
    v_lshl_add_u32 v183, v13, 4, s12
    s_lshr_b32 s11, s14, 2
    s_lshl_b32 s7, s11, 15
    s_add_u32 s19, s7, 524288
    s_add_u32 s19, s19, s17
    s_lshl_b32 s7, s14, 9
    s_add_u32 s7, s7, s15
    s_lshl_b32 s12, s7, 3
    s_add_u32 s23, s12, 2696192
    s_waitcnt vmcnt(3)
    s_add_u32 m0, s17, 35840
    s_add_u32 s8, s16, 35840
    buffer_load_dwordx4 v243, s[60:63], s8 offen nt lds
    s_mul_i32 s7, s14, 524288
    s_mul_i32 s12, s15, 1024
    s_add_u32 s7, s7, s12
    s_lshl_b32 s12, s3, 7
    s_add_u32 s7, s7, s12
    s_add_u32 s21, s7, 4194304
    s_sub_u32 s22, s21, s12
    s_mul_i32 s12, s3, 65536
    s_add_u32 s22, s22, s12
    s_lshl_b32 s12, s15, 1
    s_lshr_b32 s7, s3, 2
    s_add_u32 s12, s12, s7
    s_lshl_b32 s7, s14, 5
    s_add_u32 s7, s7, s12
    s_lshl_b32 s13, s7, 7
    s_add_u32 s25, s13, 2696192
    s_mul_i32 s7, s7, 16384
    s_and_b32 s13, s3, 3
    s_lshl_b32 s9, s13, 8
    s_add_u32 s7, s7, s9
    s_add_u32 s24, s7, 4194304
    s_lshl_b32 s7, s11, 5
    s_add_u32 s7, s7, s12
    s_lshl_b32 s7, s7, 2
    s_waitcnt vmcnt(3)
    s_add_u32 m0, s17, 65536
    s_add_u32 s8, s16, 65536
    buffer_load_dwordx4 v240, s[60:63], s8 offen nt lds
    s_and_b32 s9, s14, 3
    s_add_u32 s7, s7, s9
    s_lshl_b32 s7, s7, 11
    s_lshl_b32 s9, s13, 9
    s_add_u32 s7, s7, s9
    s_add_u32 s26, s7, 2752512
    s_mul_i32 s12, s15, 52
    s_lshr_b32 s12, s12, 8
    s_mul_i32 s13, s12, 5
    s_sub_u32 s13, s15, s13
    s_lshl_b32 s7, s14, 1
    s_add_u32 s12, s12, s7
    s_lshl_b32 s7, s12, 8
    s_lshl_b32 s9, s3, 5
    s_add_u32 s7, s7, s9
    s_mul_i32 s7, s7, 1280
    s_lshl_b32 s9, s13, 8
    s_add_u32 s20, s7, s9
    s_lshl_b32 s7, s4, 7
    s_add_u32 s30, s7, 20480
    s_waitcnt vmcnt(3)
    s_add_u32 m0, s17, 66560
    s_add_u32 s8, s16, 66560
    buffer_load_dwordx4 v241, s[60:63], s8 offen nt lds
    v_lshlrev_b32 v222, 7, v2
    s_cmp_lg_u32 s3, 7
    s_nop 0
    s_cbranch_scc1 SKIP_9
    s_lshl_b32 s10, s14, 11
    s_add_u32 s10, s10, 4096
    buffer_load_dwordx2 v[220:221], v222, s[48:51], s10 offen sc1
SKIP_9:
    s_cmp_lg_u32 s3, 6
    s_cbranch_scc1 SKIP_10
    v_min_u32 v202, 49, v1
    v_lshlrev_b32 v202, 7, v202
    s_mov_b32 s10, 0x2c000
    s_mov_b32 s8, 0x2d900
    buffer_load_dword v220, v202, s[48:51], s10 offen sc1
    buffer_load_dword v221, v202, s[48:51], s8 offen sc1
SKIP_10:
    s_waitcnt vmcnt(3)
    s_add_u32 m0, s17, 67584
    s_add_u32 s8, s16, 67584
    buffer_load_dwordx4 v242, s[60:63], s8 offen nt lds
    s_waitcnt vmcnt(3)
    s_add_u32 m0, s17, 68608
    s_add_u32 s8, s16, 68608
    buffer_load_dwordx4 v243, s[60:63], s8 offen nt lds
    s_waitcnt vmcnt(3)
    s_add_u32 m0, s17, 98304
    s_add_u32 s8, s16, 98304
    buffer_load_dwordx4 v240, s[60:63], s8 offen nt lds
    s_waitcnt vmcnt(3)
    s_add_u32 m0, s17, 99328
    s_add_u32 s8, s16, 99328
    buffer_load_dwordx4 v241, s[60:63], s8 offen nt lds
    s_waitcnt vmcnt(3)
    s_add_u32 m0, s17, 100352
    s_add_u32 s8, s16, 100352
    buffer_load_dwordx4 v242, s[60:63], s8 offen nt lds
    s_waitcnt vmcnt(3)
    s_add_u32 m0, s17, 101376
    s_add_u32 s8, s16, 101376
    buffer_load_dwordx4 v243, s[60:63], s8 offen nt lds
    s_cmp_lg_u32 s3, 5
    s_cbranch_scc1 SKIP_11
    v_mov_b32 v202, s5
    v_mov_b32 v203, 0
    s_mov_b64 exec, 1
    buffer_store_dword v202, v203, s[48:51], s30 offen sc1
    s_mov_b64 exec, -1
SKIP_11:
    s_waitcnt vmcnt(4)
    s_sub_u32 s7, s5, 1
    v_mov_b32 v208, s7
    v_mov_b32 v209, s7
    v_mov_b32 v210, s7
    v_mov_b32 v211, s7
    s_mov_b32 exec_hi, 0
    buffer_store_dwordx4 v[208:211], v9, s[48:51], s26 offen sc1
    s_mov_b64 exec, -1
    buffer_load_dword v207, v195, s[48:51], s25 offen sc1
    s_cmp_lg_u32 s3, 7
    s_cbranch_scc1 SKIP_12
    v_cmp_ne_u32 vcc, s5, v221
    s_nop 0
    s_nop 3
    s_cbranch_vccz XOK_13
    s_lshl_b32 s7, s14, 11
    s_add_u32 s7, s7, 4096
    s_mov_b32 s6, 0x186a0
POLL_14:
    buffer_load_dwordx2 v[220:221], v222, s[48:51], s7 offen sc1
    s_waitcnt vmcnt(0)
    v_cmp_ne_u32 vcc, s5, v221
    s_nop 0
    s_nop 3
    s_cbranch_vccz PDONE_15
    s_sleep 4
    s_sub_u32 s6, s6, 1
    s_cbranch_scc0 POLL_14
PDONE_15:
XOK_13:
    s_getreg_b32 s7, hwreg(HW_REG_XCC_ID)
    s_and_b32 s7, s7, 0xf
    v_cmp_ne_u32 s[8:9], s7, v220
    v_cmp_ne_u32 vcc, s5, v221
    s_nop 0
    s_or_b64 s[8:9], s[8:9], vcc
    s_cmp_eq_u64 s[8:9], 0
    s_cselect_b32 s7, 1, 0
    v_mov_b32 v202, s7
    v_mov_b32 v203, 0x22000
    ds_write_b32 v203, v202
    s_nop 0
SKIP_12:
    s_cmp_lg_u32 s3, 6
    s_cbranch_scc1 SKIP_16
    v_xor_b32 v220, s5, v220
    v_xor_b32 v221, s5, v221
    v_or_b32 v220, v220, v221
    v_cmp_ne_u32 vcc, 0, v220
    s_nop 0
    s_nop 3
    s_cbranch_vccz SKIP_16
    v_min_u32 v202, 49, v1
    v_lshlrev_b32 v202, 7, v202
    s_mov_b32 s7, 0x2c000
    s_mov_b32 s8, 0x2d900
    s_mov_b32 s6, 0x186a0
POLL_17:
    buffer_load_dword v204, v202, s[48:51], s7 offen sc1
    buffer_load_dword v205, v202, s[48:51], s8 offen sc1
    s_waitcnt vmcnt(0)
    v_xor_b32 v204, s5, v204
    v_xor_b32 v205, s5, v205
    v_or_b32 v204, v204, v205
    v_cmp_ne_u32 vcc, 0, v204
    s_nop 0
    s_nop 3
    s_cbranch_vccz PDONE_18
    s_sleep 4
    s_sub_u32 s6, s6, 1
    s_cbranch_scc0 POLL_17
PDONE_18:
SKIP_16:
    s_waitcnt lgkmcnt(0)
    s_barrier
    v_mov_b32 v202, 0x22000
    ds_read_b32 v202, v202
    s_waitcnt lgkmcnt(0)
    v_readfirstlane_b32 s47, v202
    ds_read_b64_tr_b16 v[80:81], v236 offset:0
    ds_read_b64_tr_b16 v[82:83], v236 offset:4096
    ds_read_b64_tr_b16 v[96:97], v236 offset:8
    ds_read_b64_tr_b16 v[98:99], v236 offset:4104
    ds_read_b64_tr_b16 v[112:113], v237 offset:0
    ds_read_b64_tr_b16 v[114:115], v237 offset:4096
    ds_read_b64_tr_b16 v[128:129], v237 offset:8
    ds_read_b64_tr_b16 v[130:131], v237 offset:4104
    s_lshr_b32 s10, s3, 1
    s_cmp_lg_u32 s10, 0
    s_cbranch_scc1 NOKF_19
    ds_read_b128 v[16:19], v232 offset:0
    ds_read_b128 v[20:23], v233 offset:0
    ds_read_b128 v[24:27], v234 offset:0
    ds_read_b128 v[28:31], v235 offset:0
    ds_read_b128 v[32:35], v232 offset:256
    ds_read_b128 v[36:39], v233 offset:256
    ds_read_b128 v[40:43], v234 offset:256
    ds_read_b128 v[44:47], v235 offset:256
    ds_read_b128 v[48:51], v232 offset:512
    ds_read_b128 v[52:55], v233 offset:512
    ds_read_b128 v[56:59], v234 offset:512
    ds_read_b128 v[60:63], v235 offset:512
    ds_read_b128 v[64:67], v232 offset:768
    ds_read_b128 v[68:71], v233 offset:768
    ds_read_b128 v[72:75], v234 offset:768
    ds_read_b128 v[76:79], v235 offset:768
NOKF_19:
    ds_read_b64_tr_b16 v[84:85], v236 offset:32768
    ds_read_b64_tr_b16 v[86:87], v236 offset:36864
    ds_read_b64_tr_b16 v[100:101], v236 offset:32776
    ds_read_b64_tr_b16 v[102:103], v236 offset:36872
    ds_read_b64_tr_b16 v[116:117], v237 offset:32768
    ds_read_b64_tr_b16 v[118:119], v237 offset:36864
    ds_read_b64_tr_b16 v[132:133], v237 offset:32776
    ds_read_b64_tr_b16 v[134:135], v237 offset:36872
    s_lshr_b32 s10, s3, 1
    s_cmp_lg_u32 s10, 1
    s_cbranch_scc1 NOKF_20
    ds_read_b128 v[16:19], v232 offset:0
    ds_read_b128 v[20:23], v233 offset:0
    ds_read_b128 v[24:27], v234 offset:0
    ds_read_b128 v[28:31], v235 offset:0
    ds_read_b128 v[32:35], v232 offset:256
    ds_read_b128 v[36:39], v233 offset:256
    ds_read_b128 v[40:43], v234 offset:256
    ds_read_b128 v[44:47], v235 offset:256
    ds_read_b128 v[48:51], v232 offset:512
    ds_read_b128 v[52:55], v233 offset:512
    ds_read_b128 v[56:59], v234 offset:512
    ds_read_b128 v[60:63], v235 offset:512
    ds_read_b128 v[64:67], v232 offset:768
    ds_read_b128 v[68:71], v233 offset:768
    ds_read_b128 v[72:75], v234 offset:768
    ds_read_b128 v[76:79], v235 offset:768
NOKF_20:
    ds_read_b64_tr_b16 v[88:89], v238 offset:0
    ds_read_b64_tr_b16 v[90:91], v238 offset:4096
    ds_read_b64_tr_b16 v[104:105], v238 offset:8
    ds_read_b64_tr_b16 v[106:107], v238 offset:4104
    ds_read_b64_tr_b16 v[120:121], v239 offset:0
    ds_read_b64_tr_b16 v[122:123], v239 offset:4096
    ds_read_b64_tr_b16 v[136:137], v239 offset:8
    ds_read_b64_tr_b16 v[138:139], v239 offset:4104
    s_lshr_b32 s10, s3, 1
    s_cmp_lg_u32 s10, 2
    s_cbranch_scc1 NOKF_21
    ds_read_b128 v[16:19], v232 offset:0
    ds_read_b128 v[20:23], v233 offset:0
    ds_read_b128 v[24:27], v234 offset:0
    ds_read_b128 v[28:31], v235 offset:0
    ds_read_b128 v[32:35], v232 offset:256
    ds_read_b128 v[36:39], v233 offset:256
    ds_read_b128 v[40:43], v234 offset:256
    ds_read_b128 v[44:47], v235 offset:256
    ds_read_b128 v[48:51], v232 offset:512
    ds_read_b128 v[52:55], v233 offset:512
    ds_read_b128 v[56:59], v234 offset:512
    ds_read_b128 v[60:63], v235 offset:512
    ds_read_b128 v[64:67], v232 offset:768
    ds_read_b128 v[68:71], v233 offset:768
    ds_read_b128 v[72:75], v234 offset:768
    ds_read_b128 v[76:79], v235 offset:768
NOKF_21:
    s_waitcnt vmcnt(1)
    s_barrier
    ds_read_b64_tr_b16 v[92:93], v238 offset:32768
    ds_read_b64_tr_b16 v[94:95], v238 offset:36864
    ds_read_b64_tr_b16 v[108:109], v238 offset:32776
    ds_read_b64_tr_b16 v[110:111], v238 offset:36872
    ds_read_b64_tr_b16 v[124:125], v239 offset:32768
    ds_read_b64_tr_b16 v[126:127], v239 offset:36864
    ds_read_b64_tr_b16 v[140:141], v239 offset:32776
    ds_read_b64_tr_b16 v[142:143], v239 offset:36872
    s_lshr_b32 s10, s3, 1
    s_cmp_lg_u32 s10, 3
    s_cbranch_scc1 NOKF_22
    ds_read_b128 v[16:19], v232 offset:0
    ds_read_b128 v[20:23], v233 offset:0
    ds_read_b128 v[24:27], v234 offset:0
    ds_read_b128 v[28:31], v235 offset:0
    ds_read_b128 v[32:35], v232 offset:256
    ds_read_b128 v[36:39], v233 offset:256
    ds_read_b128 v[40:43], v234 offset:256
    ds_read_b128 v[44:47], v235 offset:256
    ds_read_b128 v[48:51], v232 offset:512
    ds_read_b128 v[52:55], v233 offset:512
    ds_read_b128 v[56:59], v234 offset:512
    ds_read_b128 v[60:63], v235 offset:512
    ds_read_b128 v[64:67], v232 offset:768
    ds_read_b128 v[68:71], v233 offset:768
    ds_read_b128 v[72:75], v234 offset:768
    ds_read_b128 v[76:79], v235 offset:768
NOKF_22:
    s_cmp_lg_u32 s3, 4
    s_cbranch_scc1 SKIP_23
    v_mul_u32_u24 v203, 9, v1
    v_add_u32 v203, s4, v203
    v_and_b32 v203, 127, v203
    v_lshlrev_b32 v203, 7, v203
    s_mov_b32 s7, 0x24000
    s_mov_b64 exec, 0xffff
    s_mov_b32 s6, 0x186a0
POLL_24:
    buffer_load_dword v202, v203, s[48:51], s7 offen sc1
    s_waitcnt vmcnt(0)
    v_cmp_ne_u32 vcc, s5, v202
    s_nop 0
    s_nop 3
    s_cbranch_vccz PDONE_25
    s_sub_u32 s6, s6, 1
    s_cbranch_scc0 POLL_24
PDONE_25:
    s_mov_b64 exec, -1
SKIP_23:
    s_barrier
    s_mov_b32 s6, 0x186a0
    s_add_u32 m0, s18, 0
    s_add_u32 s8, s19, 0
    buffer_load_dwordx4 v240, s[48:51], s8 offen sc1 lds
    s_add_u32 m0, s18, 1024
    s_add_u32 s8, s19, 1024
    buffer_load_dwordx4 v241, s[48:51], s8 offen sc1 lds
    s_add_u32 m0, s18, 2048
    s_add_u32 s8, s19, 2048
    buffer_load_dwordx4 v242, s[48:51], s8 offen sc1 lds
    s_add_u32 m0, s18, 3072
    s_add_u32 s8, s19, 3072
    buffer_load_dwordx4 v243, s[48:51], s8 offen sc1 lds
    s_waitcnt vmcnt(0)
    s_branch L_E2_CHECK
L_E2_RETRY:
    s_sleep 6
    s_add_u32 m0, s18, 0
    s_add_u32 s8, s19, 0
    buffer_load_dwordx4 v240, s[48:51], s8 offen sc1 lds
    s_add_u32 m0, s18, 1024
    s_add_u32 s8, s19, 1024
    buffer_load_dwordx4 v241, s[48:51], s8 offen sc1 lds
    s_add_u32 m0, s18, 2048
    s_add_u32 s8, s19, 2048
    buffer_load_dwordx4 v242, s[48:51], s8 offen sc1 lds
    s_add_u32 m0, s18, 3072
    s_add_u32 s8, s19, 3072
    buffer_load_dwordx4 v243, s[48:51], s8 offen sc1 lds
    s_waitcnt vmcnt(0)
L_E2_CHECK:
    ds_read_b128 v[144:147], v255 offset:0
    ds_read_b128 v[148:151], v255 offset:1024
    ds_read_b128 v[152:155], v255 offset:2048
    ds_read_b128 v[156:159], v255 offset:3072
    s_waitcnt lgkmcnt(0)
    v_max3_u32 v160, v144, v146, v148
    v_max3_u32 v161, v145, v147, v149
    v_max3_u32 v160, v160, v150, v152
    v_max3_u32 v161, v161, v151, v153
    v_max3_u32 v160, v160, v154, v156
    v_max3_u32 v161, v161, v155, v157
    v_max_u32 v160, v160, v158
    v_max_u32 v161, v161, v159
    v_max_u32 v160, v160, v161
    v_cmp_eq_u32 vcc, -1, v160
    s_nop 0
    s_nop 3
    s_cbranch_vccz PDONE_26
    s_sub_u32 s6, s6, 1
    s_cbranch_scc0 L_E2_RETRY
PDONE_26:
    s_barrier
    ds_read_b128 v[144:147], v224 offset:0
    ds_read_b128 v[148:151], v224 offset:16384
    ds_read_b128 v[152:155], v225 offset:0
    ds_read_b128 v[156:159], v225 offset:16384
    ds_read_b128 v[160:163], v226 offset:0
    ds_read_b128 v[164:167], v226 offset:16384
    s_waitcnt lgkmcnt(5)
    v_mfma_f32_16x16x32_bf16 v[244:247], v[16:19], v[144:147], 0
    ds_read_b128 v[168:171], v227 offset:0
    s_waitcnt lgkmcnt(5)
    v_mfma_f32_16x16x32_bf16 v[248:251], v[16:19], v[148:151], 0
    ds_read_b128 v[172:175], v227 offset:16384
    s_waitcnt lgkmcnt(5)
    v_mfma_f32_16x16x32_bf16 v[244:247], v[20:23], v[152:155], v[244:247]
    ds_read_b128 v[144:147], v224 offset:256
    s_waitcnt lgkmcnt(5)
    v_mfma_f32_16x16x32_bf16 v[248:251], v[20:23], v[156:159], v[248:251]
    ds_read_b128 v[148:151], v224 offset:16640
    s_waitcnt lgkmcnt(5)
    v_mfma_f32_16x16x32_bf16 v[244:247], v[24:27], v[160:163], v[244:247]
    ds_read_b128 v[152:155], v225 offset:256
    s_waitcnt lgkmcnt(5)
    v_mfma_f32_16x16x32_bf16 v[248:251], v[24:27], v[164:167], v[248:251]
    ds_read_b128 v[156:159], v225 offset:16640
    s_waitcnt lgkmcnt(5)
    v_mfma_f32_16x16x32_bf16 v[244:247], v[28:31], v[168:171], v[244:247]
    ds_read_b128 v[160:163], v226 offset:256
    s_waitcnt lgkmcnt(5)
    v_mfma_f32_16x16x32_bf16 v[248:251], v[28:31], v[172:175], v[248:251]
    ds_read_b128 v[164:167], v226 offset:16640
    s_waitcnt lgkmcnt(5)
    v_mfma_f32_16x16x32_bf16 v[244:247], v[32:35], v[144:147], v[244:247]
    ds_read_b128 v[168:171], v227 offset:256
    s_waitcnt lgkmcnt(5)
    v_mfma_f32_16x16x32_bf16 v[248:251], v[32:35], v[148:151], v[248:251]
    ds_read_b128 v[172:175], v227 offset:16640
    s_waitcnt lgkmcnt(5)
    v_mfma_f32_16x16x32_bf16 v[244:247], v[36:39], v[152:155], v[244:247]
    ds_read_b128 v[144:147], v224 offset:512
    s_waitcnt lgkmcnt(5)
    v_mfma_f32_16x16x32_bf16 v[248:251], v[36:39], v[156:159], v[248:251]
    ds_read_b128 v[148:151], v224 offset:16896
    s_waitcnt lgkmcnt(5)
    v_mfma_f32_16x16x32_bf16 v[244:247], v[40:43], v[160:163], v[244:247]
    ds_read_b128 v[152:155], v225 offset:512
    s_waitcnt lgkmcnt(5)
    v_mfma_f32_16x16x32_bf16 v[248:251], v[40:43], v[164:167], v[248:251]
    ds_read_b128 v[156:159], v225 offset:16896
    s_waitcnt lgkmcnt(5)
    v_mfma_f32_16x16x32_bf16 v[244:247], v[44:47], v[168:171], v[244:247]
    ds_read_b128 v[160:163], v226 offset:512
    s_waitcnt lgkmcnt(5)
    v_mfma_f32_16x16x32_bf16 v[248:251], v[44:47], v[172:175], v[248:251]
    ds_read_b128 v[164:167], v226 offset:16896
    s_waitcnt lgkmcnt(5)
    v_mfma_f32_16x16x32_bf16 v[244:247], v[48:51], v[144:147], v[244:247]
    ds_read_b128 v[168:171], v227 offset:512
    s_waitcnt lgkmcnt(5)
    v_mfma_f32_16x16x32_bf16 v[248:251], v[48:51], v[148:151], v[248:251]
    ds_read_b128 v[172:175], v227 offset:16896
    s_waitcnt lgkmcnt(5)
    v_mfma_f32_16x16x32_bf16 v[244:247], v[52:55], v[152:155], v[244:247]
    ds_read_b128 v[144:147], v224 offset:768
    s_waitcnt lgkmcnt(5)
    v_mfma_f32_16x16x32_bf16 v[248:251], v[52:55], v[156:159], v[248:251]
    ds_read_b128 v[148:151], v224 offset:17152
    s_waitcnt lgkmcnt(5)
    v_mfma_f32_16x16x32_bf16 v[244:247], v[56:59], v[160:163], v[244:247]
    ds_read_b128 v[152:155], v225 offset:768
    s_waitcnt lgkmcnt(5)
    v_mfma_f32_16x16x32_bf16 v[248:251], v[56:59], v[164:167], v[248:251]
    ds_read_b128 v[156:159], v225 offset:17152
    s_waitcnt lgkmcnt(5)
    v_mfma_f32_16x16x32_bf16 v[244:247], v[60:63], v[168:171], v[244:247]
    ds_read_b128 v[160:163], v226 offset:768
    s_waitcnt lgkmcnt(5)
    v_mfma_f32_16x16x32_bf16 v[248:251], v[60:63], v[172:175], v[248:251]
    ds_read_b128 v[164:167], v226 offset:17152
    s_waitcnt lgkmcnt(5)
    v_mfma_f32_16x16x32_bf16 v[244:247], v[64:67], v[144:147], v[244:247]
    ds_read_b128 v[168:171], v227 offset:768
    s_waitcnt lgkmcnt(5)
    v_mfma_f32_16x16x32_bf16 v[248:251], v[64:67], v[148:151], v[248:251]
    ds_read_b128 v[172:175], v227 offset:17152
    s_waitcnt lgkmcnt(5)
    v_mfma_f32_16x16x32_bf16 v[244:247], v[68:71], v[152:155], v[244:247]
    s_waitcnt lgkmcnt(4)
    v_mfma_f32_16x16x32_bf16 v[248:251], v[68:71], v[156:159], v[248:251]
    s_waitcnt lgkmcnt(3)
    v_mfma_f32_16x16x32_bf16 v[244:247], v[72:75], v[160:163], v[244:247]
    s_waitcnt lgkmcnt(2)
    v_mfma_f32_16x16x32_bf16 v[248:251], v[72:75], v[164:167], v[248:251]
    s_waitcnt lgkmcnt(1)
    v_mfma_f32_16x16x32_bf16 v[244:247], v[76:79], v[168:171], v[244:247]
    s_waitcnt lgkmcnt(0)
    v_mfma_f32_16x16x32_bf16 v[248:251], v[76:79], v[172:175], v[248:251]
    s_mov_b32 s7, 0x3fb8aa3b
    s_nop 4
    v_cvt_pk_bf16_f32 v16, v244, v245
    v_cvt_pk_bf16_f32 v17, v246, v247
    v_cvt_pk_bf16_f32 v18, v248, v249
    v_cvt_pk_bf16_f32 v19, v250, v251
    v_lshlrev_b32 v244, 16, v16
    v_and_b32 v245, 0xffff0000, v16
    v_lshlrev_b32 v246, 16, v17
    v_and_b32 v247, 0xffff0000, v17
    v_lshlrev_b32 v248, 16, v18
    v_and_b32 v249, 0xffff0000, v18
    v_lshlrev_b32 v250, 16, v19
    v_and_b32 v251, 0xffff0000, v19
    v_mul_f32 v244, 0x3db504f3, v244
    v_mul_f32 v245, 0x3db504f3, v245
    v_mul_f32 v246, 0x3db504f3, v246
    v_mul_f32 v247, 0x3db504f3, v247
    v_mul_f32 v248, 0x3db504f3, v248
    v_mul_f32 v249, 0x3db504f3, v249
    v_mul_f32 v250, 0x3db504f3, v250
    v_mul_f32 v251, 0x3db504f3, v251
    v_cvt_pk_bf16_f32 v16, v244, v245
    v_cvt_pk_bf16_f32 v17, v246, v247
    v_cvt_pk_bf16_f32 v18, v248, v249
    v_cvt_pk_bf16_f32 v19, v250, v251
    v_lshlrev_b32 v244, 16, v16
    v_and_b32 v245, 0xffff0000, v16
    v_lshlrev_b32 v246, 16, v17
    v_and_b32 v247, 0xffff0000, v17
    v_lshlrev_b32 v248, 16, v18
    v_and_b32 v249, 0xffff0000, v18
    v_lshlrev_b32 v250, 16, v19
    v_and_b32 v251, 0xffff0000, v19
    v_max3_f32 v16, v244, v245, v246
    v_max3_f32 v17, v248, v249, v250
    v_max_f32 v16, v16, v247
    v_max_f32 v17, v17, v251
    s_nop 1
    v_permlane32_swap_b32 v16, v17
    v_max_f32 v16, v16, v17
    v_mov_b32 v17, v16
    s_nop 1
    v_permlane16_swap_b32 v16, v17
    v_max_f32 v16, v16, v17
    ds_write_b32 v254, v16 offset:0
    v_mul_f32 v244, s7, v244
    v_mul_f32 v245, s7, v245
    v_mul_f32 v246, s7, v246
    v_mul_f32 v247, s7, v247
    v_mul_f32 v248, s7, v248
    v_mul_f32 v249, s7, v249
    v_mul_f32 v250, s7, v250
    v_mul_f32 v251, s7, v251
    s_waitcnt lgkmcnt(0)
    s_barrier
    ds_read_b128 v[20:23], v253 offset:0
    ds_read_b128 v[24:27], v253 offset:16
    s_waitcnt lgkmcnt(1)
    v_max3_f32 v16, v20, v21, v22
    s_waitcnt lgkmcnt(0)
    v_max3_f32 v17, v24, v25, v26
    v_max3_f32 v16, v16, v23, v27
    v_max_f32 v16, v16, v17
    v_mul_f32 v16, s7, v16
    v_mov_b32 v17, v16
    v_mov_b32 v28, v16
    s_nop 0
    v_permlane32_swap_b32 v16, v17
    v_sub_f32 v244, v244, v16
    v_sub_f32 v245, v245, v16
    v_sub_f32 v246, v246, v16
    v_sub_f32 v247, v247, v16
    v_sub_f32 v248, v248, v17
    v_sub_f32 v249, v249, v17
    v_sub_f32 v250, v250, v17
    v_sub_f32 v251, v251, v17
    v_exp_f32 v244, v244
    v_exp_f32 v245, v245
    v_exp_f32 v246, v246
    v_exp_f32 v247, v247
    v_exp_f32 v248, v248
    v_exp_f32 v249, v249
    v_exp_f32 v250, v250
    v_exp_f32 v251, v251
    v_cvt_pk_bf16_f32 v20, v244, v245
    v_cvt_pk_bf16_f32 v21, v246, v247
    v_cvt_pk_bf16_f32 v22, v248, v249
    v_cvt_pk_bf16_f32 v23, v250, v251
    ds_write_b64 v252, v[20:21] offset:4096
    ds_write_b64 v252, v[22:23] offset:8192
    v_add_f32 v16, v244, v245
    v_add_f32 v24, v246, v247
    v_add_f32 v17, v248, v249
    v_add_f32 v25, v250, v251
    v_add_f32 v16, v16, v24
    v_add_f32 v17, v17, v25
    s_nop 1
    v_permlane32_swap_b32 v16, v17
    v_add_f32 v16, v16, v17
    v_mov_b32 v17, v16
    s_nop 1
    v_permlane16_swap_b32 v16, v17
    v_add_f32 v16, v16, v17
    ds_write_b32 v254, v16 offset:1024
    s_waitcnt lgkmcnt(0)
    s_barrier
    ds_read_b128 v[32:35], v228 offset:4096
    ds_read_b128 v[36:39], v229 offset:4096
    ds_read_b128 v[40:43], v230 offset:4096
    ds_read_b128 v[44:47], v231 offset:4096
    ds_read_b128 v[20:23], v253 offset:1024
    ds_read_b128 v[24:27], v253 offset:1040
    ds_read_b128 v[48:51], v228 offset:8192
    ds_read_b128 v[52:55], v229 offset:8192
    ds_read_b128 v[56:59], v230 offset:8192
    ds_read_b128 v[60:63], v231 offset:8192
    s_waitcnt lgkmcnt(9)
    v_mfma_f32_16x16x32_bf16 v[144:147], v[80:83], v[32:35], 0
    v_mfma_f32_16x16x32_bf16 v[152:155], v[96:99], v[32:35], 0
    v_mfma_f32_16x16x32_bf16 v[160:163], v[112:115], v[32:35], 0
    v_mfma_f32_16x16x32_bf16 v[168:171], v[128:131], v[32:35], 0
    s_waitcnt lgkmcnt(8)
    v_mfma_f32_16x16x32_bf16 v[144:147], v[84:87], v[36:39], v[144:147]
    v_mfma_f32_16x16x32_bf16 v[152:155], v[100:103], v[36:39], v[152:155]
    v_mfma_f32_16x16x32_bf16 v[160:163], v[116:119], v[36:39], v[160:163]
    v_mfma_f32_16x16x32_bf16 v[168:171], v[132:135], v[36:39], v[168:171]
    s_waitcnt lgkmcnt(4)
    v_mfma_f32_16x16x32_bf16 v[144:147], v[88:91], v[40:43], v[144:147]
    v_add_f32 v20, v20, v21
    v_add_f32 v22, v22, v23
    v_mfma_f32_16x16x32_bf16 v[152:155], v[104:107], v[40:43], v[152:155]
    v_add_f32 v24, v24, v25
    v_add_f32 v26, v26, v27
    v_mfma_f32_16x16x32_bf16 v[160:163], v[120:123], v[40:43], v[160:163]
    v_add_f32 v20, v20, v22
    v_add_f32 v24, v24, v26
    v_mfma_f32_16x16x32_bf16 v[168:171], v[136:139], v[40:43], v[168:171]
    v_add_f32 v20, v20, v24
    v_rcp_f32 v16, v20
    s_waitcnt lgkmcnt(4)
    v_mfma_f32_16x16x32_bf16 v[144:147], v[92:95], v[44:47], v[144:147]
    v_log_f32 v21, v20
    v_mov_b32 v17, v16
    v_mfma_f32_16x16x32_bf16 v[152:155], v[108:111], v[44:47], v[152:155]
    v_add_f32 v28, v28, v21
    v_permlane32_swap_b32 v16, v17
    v_mfma_f32_16x16x32_bf16 v[160:163], v[124:127], v[44:47], v[160:163]
    v_mov_b32 v29, s5
    v_mfma_f32_16x16x32_bf16 v[168:171], v[140:143], v[44:47], v[168:171]
    s_waitcnt lgkmcnt(3)
    v_mfma_f32_16x16x32_bf16 v[148:151], v[80:83], v[48:51], 0
    v_mfma_f32_16x16x32_bf16 v[156:159], v[96:99], v[48:51], 0
    v_mfma_f32_16x16x32_bf16 v[164:167], v[112:115], v[48:51], 0
    v_mul_f32 v144, v144, v16
    v_mul_f32 v145, v145, v16
    v_mul_f32 v146, v146, v16
    v_mul_f32 v147, v147, v16
    v_mfma_f32_16x16x32_bf16 v[172:175], v[128:131], v[48:51], 0
    v_cvt_pk_bf16_f32 v64, v144, v145
    v_cvt_pk_bf16_f32 v65, v146, v147
    v_mul_f32 v152, v152, v16
    v_mul_f32 v153, v153, v16
    s_waitcnt lgkmcnt(2)
    v_mfma_f32_16x16x32_bf16 v[148:151], v[84:87], v[52:55], v[148:151]
    v_mul_f32 v154, v154, v16
    v_mul_f32 v155, v155, v16
    v_cvt_pk_bf16_f32 v66, v152, v153
    v_cvt_pk_bf16_f32 v67, v154, v155
    v_mfma_f32_16x16x32_bf16 v[156:159], v[100:103], v[52:55], v[156:159]
    v_mul_f32 v160, v160, v16
    v_mul_f32 v161, v161, v16
    v_mul_f32 v162, v162, v16
    v_mul_f32 v163, v163, v16
    v_mfma_f32_16x16x32_bf16 v[164:167], v[116:119], v[52:55], v[164:167]
    v_cvt_pk_bf16_f32 v68, v160, v161
    v_cvt_pk_bf16_f32 v69, v162, v163
    v_mul_f32 v168, v168, v16
    v_mul_f32 v169, v169, v16
    v_mfma_f32_16x16x32_bf16 v[172:175], v[132:135], v[52:55], v[172:175]
    v_mul_f32 v170, v170, v16
    v_mul_f32 v171, v171, v16
    v_cvt_pk_bf16_f32 v70, v168, v169
    v_cvt_pk_bf16_f32 v71, v170, v171
    s_waitcnt lgkmcnt(1)
    v_mfma_f32_16x16x32_bf16 v[148:151], v[88:91], v[56:59], v[148:151]
    ds_write_b128 v176, v[64:67] offset:32768
    ds_write_b128 v177, v[68:71] offset:32768
    v_mfma_f32_16x16x32_bf16 v[156:159], v[104:107], v[56:59], v[156:159]
    v_mfma_f32_16x16x32_bf16 v[164:167], v[120:123], v[56:59], v[164:167]
    v_mfma_f32_16x16x32_bf16 v[172:175], v[136:139], v[56:59], v[172:175]
    s_waitcnt lgkmcnt(0)
    v_mfma_f32_16x16x32_bf16 v[148:151], v[92:95], v[60:63], v[148:151]
    v_mfma_f32_16x16x32_bf16 v[156:159], v[108:111], v[60:63], v[156:159]
    v_mfma_f32_16x16x32_bf16 v[164:167], v[124:127], v[60:63], v[164:167]
    v_mfma_f32_16x16x32_bf16 v[172:175], v[140:143], v[60:63], v[172:175]
    s_nop 4
    v_mul_f32 v148, v148, v17
    v_mul_f32 v149, v149, v17
    v_mul_f32 v150, v150, v17
    v_mul_f32 v151, v151, v17
    v_cvt_pk_bf16_f32 v72, v148, v149
    v_cvt_pk_bf16_f32 v73, v150, v151
    v_mul_f32 v156, v156, v17
    v_mul_f32 v157, v157, v17
    v_mul_f32 v158, v158, v17
    v_mul_f32 v159, v159, v17
    v_cvt_pk_bf16_f32 v74, v156, v157
    v_cvt_pk_bf16_f32 v75, v158, v159
    v_mul_f32 v164, v164, v17
    v_mul_f32 v165, v165, v17
    v_mul_f32 v166, v166, v17
    v_mul_f32 v167, v167, v17
    v_cvt_pk_bf16_f32 v76, v164, v165
    v_cvt_pk_bf16_f32 v77, v166, v167
    v_mul_f32 v172, v172, v17
    v_mul_f32 v173, v173, v17
    v_mul_f32 v174, v174, v17
    v_mul_f32 v175, v175, v17
    v_cvt_pk_bf16_f32 v78, v172, v173
    v_cvt_pk_bf16_f32 v79, v174, v175
    ds_write_b128 v176, v[72:75] offset:49152
    ds_write_b128 v177, v[76:79] offset:49152
    s_waitcnt lgkmcnt(0)
    s_barrier
    ds_read_b128 v[144:147], v180 offset:32768
    ds_read_b128 v[148:151], v181 offset:32768
    ds_read_b128 v[152:155], v182 offset:32768
    ds_read_b128 v[156:159], v183 offset:32768
    s_cmp_eq_u32 s47, 1
    s_cbranch_scc1 LOC_27
    s_waitcnt lgkmcnt(3)
    s_add_u32 s8, s22, 0
    buffer_store_dwordx4 v[144:147], v8, s[48:51], s8 offen sc1
    s_waitcnt lgkmcnt(2)
    s_add_u32 s8, s22, 16384
    buffer_store_dwordx4 v[148:151], v8, s[48:51], s8 offen sc1
    s_waitcnt lgkmcnt(1)
    s_add_u32 s8, s22, 32768
    buffer_store_dwordx4 v[152:155], v8, s[48:51], s8 offen sc1
    s_waitcnt lgkmcnt(0)
    s_add_u32 s8, s22, 49152
    buffer_store_dwordx4 v[156:159], v8, s[48:51], s8 offen sc1
    s_nop 1
    s_branch LOCJ_28
LOC_27:
    s_waitcnt lgkmcnt(3)
    s_add_u32 s8, s22, 0
    buffer_store_dwordx4 v[144:147], v8, s[48:51], s8 offen
    s_waitcnt lgkmcnt(2)
    s_add_u32 s8, s22, 16384
    buffer_store_dwordx4 v[148:151], v8, s[48:51], s8 offen
    s_waitcnt lgkmcnt(1)
    s_add_u32 s8, s22, 32768
    buffer_store_dwordx4 v[152:155], v8, s[48:51], s8 offen
    s_waitcnt lgkmcnt(0)
    s_add_u32 s8, s22, 49152
    buffer_store_dwordx4 v[156:159], v8, s[48:51], s8 offen
    s_nop 1
LOCJ_28:
    s_waitcnt vmcnt(0)
    s_barrier
    s_cmp_lg_u32 s3, 0
    s_cbranch_scc1 SKIP_29
    s_mov_b32 exec_lo, 0xffff
    s_mov_b32 exec_hi, 0xffff
    s_cmp_eq_u32 s47, 1
    s_cbranch_scc1 LOC_30
    buffer_store_dwordx2 v[28:29], v193, s[48:51], s23 offen sc1
    s_branch LOCJ_31
LOC_30:
    buffer_store_dwordx2 v[28:29], v193, s[48:51], s23 offen
LOCJ_31:
    s_mov_b64 exec, -1
SKIP_29:
    s_sleep 2
    s_mov_b32 s6, 0x186a0
POLL_32:
    buffer_load_dwordx4 v[96:99], v195, s[48:51], s25 offen sc1
    buffer_load_dwordx4 v[100:103], v195, s[48:51], s25 offen offset:16 sc1
    s_waitcnt vmcnt(0)
    v_xor_b32 v97, s5, v97
    v_xor_b32 v99, s5, v99
    v_xor_b32 v101, s5, v101
    v_xor_b32 v103, s5, v103
    v_or3_b32 v97, v97, v99, v101
    v_or_b32 v97, v97, v103
    v_cmp_ne_u32 vcc, 0, v97
    s_nop 0
    s_nop 3
    s_cbranch_vccz PDONE_33
    s_sub_u32 s6, s6, 1
    s_cbranch_scc0 POLL_32
PDONE_33:
    buffer_load_dwordx4 v[80:83], v194, s[48:51], s24 offen offset:0 sc1
    buffer_load_dwordx4 v[84:87], v194, s[48:51], s24 offen offset:1024 sc1
    buffer_load_dwordx4 v[88:91], v194, s[48:51], s24 offen offset:2048 sc1
    buffer_load_dwordx4 v[92:95], v194, s[48:51], s24 offen offset:3072 sc1
    v_max3_f32 v104, v96, v98, v100
    v_max_f32 v104, v104, v102
    v_mov_b32 v105, v104
    s_nop 1
    v_permlane16_swap_b32 v104, v105
    v_max_f32 v104, v104, v105
    v_mov_b32 v105, v104
    s_nop 1
    v_permlane32_swap_b32 v104, v105
    v_max_f32 v104, v104, v105
    v_sub_f32 v96, v96, v104
    v_sub_f32 v98, v98, v104
    v_sub_f32 v100, v100, v104
    v_sub_f32 v102, v102, v104
    v_exp_f32 v96, v96
    v_exp_f32 v98, v98
    v_exp_f32 v100, v100
    v_exp_f32 v102, v102
    v_cvt_pk_bf16_f32 v96, v96, v96
    v_cvt_pk_bf16_f32 v98, v98, v98
    v_cvt_pk_bf16_f32 v100, v100, v100
    v_cvt_pk_bf16_f32 v102, v102, v102
    v_and_b32 v97, 0xffff0000, v96
    v_and_b32 v99, 0xffff0000, v98
    v_and_b32 v101, 0xffff0000, v100
    v_and_b32 v103, 0xffff0000, v102
    v_add_f32 v105, v97, v99
    v_add_f32 v106, v101, v103
    v_add_f32 v105, v105, v106
    v_mov_b32 v106, v105
    s_nop 1
    v_permlane16_swap_b32 v105, v106
    v_add_f32 v105, v105, v106
    v_mov_b32 v106, v105
    s_nop 1
    v_permlane32_swap_b32 v105, v106
    v_add_f32 v105, v105, v106
    v_rcp_f32 v106, v105
    v_log_f32 v105, v105
    v_and_b32 v112, v96, v4
    v_and_b32 v113, v96, v5
    v_and_b32 v114, v96, v6
    v_and_b32 v115, v96, v7
    v_and_b32 v116, v98, v4
    v_and_b32 v117, v98, v5
    v_and_b32 v118, v98, v6
    v_and_b32 v119, v98, v7
    v_and_b32 v120, v100, v4
    v_and_b32 v121, v100, v5
    v_and_b32 v122, v100, v6
    v_and_b32 v123, v100, v7
    v_and_b32 v124, v102, v4
    v_and_b32 v125, v102, v5
    v_and_b32 v126, v102, v6
    v_and_b32 v127, v102, v7
    v_add_f32 v130, v104, v105
    v_mov_b32 v131, s5
    s_waitcnt vmcnt(3)
    v_mfma_f32_16x16x32_bf16 v[108:111], v[112:115], v[80:83], 0
    s_waitcnt vmcnt(2)
    v_mfma_f32_16x16x32_bf16 v[108:111], v[116:119], v[84:87], v[108:111]
    s_waitcnt vmcnt(1)
    v_mfma_f32_16x16x32_bf16 v[108:111], v[120:123], v[88:91], v[108:111]
    s_waitcnt vmcnt(0)
    v_mfma_f32_16x16x32_bf16 v[108:111], v[124:127], v[92:95], v[108:111]
    s_mov_b32 exec_hi, 0
    s_nop 6
    v_mul_f32 v108, v108, v106
    v_mul_f32 v109, v109, v106
    v_mul_f32 v110, v110, v106
    v_mul_f32 v111, v111, v106
    v_cvt_pk_bf16_f32 v128, v108, v109
    v_cvt_pk_bf16_f32 v129, v110, v111
    s_nop 0
    buffer_store_dwordx4 v[128:131], v9, s[48:51], s26 offen sc1
    s_mov_b64 exec, -1
    s_cmp_lt_u32 s4, 88
    s_cbranch_scc1 L_DONE
    s_sub_u32 s9, s4, 88
    s_lshl_b32 s9, s9, 7
    v_bfe_u32 v12, v0, 3, 6
    v_mul_u32_u24 v13, 5120, v12
    v_and_b32 v14, 7, v0
    v_lshl_add_u32 v13, v14, 4, v13
    v_cmp_gt_u32 s[18:19], 44, v12
    s_add_u32 s11, s9, 2143232
    s_add_u32 s10, s11, 327680
    v_lshlrev_b32 v12, 3, v1
    s_lshr_b32 s16, s9, 1
    s_cmp_lg_u32 s3, 0
    s_cbranch_scc1 SKIP_34
    s_add_u32 s12, s9, 2102272
    s_add_u32 s17, s9, 2122752
    s_add_u32 s13, s9, 2138112
    s_mov_b64 exec, 0xff
    s_mov_b32 s6, 0x186a0
POLL_35:
    buffer_load_dwordx4 v[96:99], v8, s[48:51], s12 offen sc1
    buffer_load_dwordx4 v[120:123], v8, s[48:51], s17 offen sc1
    buffer_load_dwordx4 v[100:103], v8, s[48:51], s13 offen sc1
    s_waitcnt vmcnt(0)
    v_xor_b32 v98, s5, v98
    v_xor_b32 v102, s5, v102
    v_xor_b32 v122, s5, v122
    v_or3_b32 v98, v98, v102, v122
    v_cmp_ne_u32 vcc, 0, v98
    s_nop 0
    s_nop 3
    s_cbranch_vccz PDONE_36
    s_sleep 1
    s_sub_u32 s6, s6, 1
    s_cbranch_scc0 POLL_35
PDONE_36:
    s_mov_b64 exec, -1
SKIP_34:
    s_barrier
    v_perm_b32 v104, v96, v99, s43
    v_perm_b32 v105, v96, v99, s44
    v_perm_b32 v106, v97, v99, s45
    v_perm_b32 v107, v97, v99, s46
    v_perm_b32 v108, v120, v123, s43
    v_perm_b32 v109, v120, v123, s44
    v_perm_b32 v110, v121, v123, s45
    v_perm_b32 v111, v121, v123, s46
    v_pk_add_f32 v[104:105], v[104:105], v[108:109]
    v_pk_add_f32 v[106:107], v[106:107], v[110:111]
    v_cvt_pk_bf16_f32 v104, v104, v104
    v_cvt_pk_bf16_f32 v105, v105, v105
    v_cvt_pk_bf16_f32 v106, v106, v106
    v_cvt_pk_bf16_f32 v107, v107, v107
    v_and_b32 v104, 0xffff0000, v104
    v_and_b32 v105, 0xffff0000, v105
    v_and_b32 v106, 0xffff0000, v106
    v_and_b32 v107, 0xffff0000, v107
    v_perm_b32 v108, v100, v103, s43
    v_perm_b32 v109, v100, v103, s44
    v_perm_b32 v110, v101, v103, s45
    v_perm_b32 v111, v101, v103, s46
    s_sleep 40
    s_mov_b32 s6, 0x186a0
POLL_37:
    v_mov_b32 v84, 0
    v_mov_b32 v85, 0
    v_mov_b32 v87, 0
    v_mov_b32 v86, s5
    buffer_load_dwordx4 v[80:83], v13, s[48:51], s11 offen sc1
    s_mov_b64 exec, s[18:19]
    s_cbranch_execz NO2_38
    buffer_load_dwordx4 v[84:87], v13, s[48:51], s10 offen sc1
NO2_38:
    s_mov_b64 exec, -1
    s_waitcnt vmcnt(0)
    v_xor_b32 v82, s5, v82
    v_xor_b32 v86, s5, v86
    v_or_b32 v82, v82, v86
    v_cmp_ne_u32 vcc, 0, v82
    s_nop 0
    s_nop 3
    s_cbranch_vccz PDONE_39
    s_sleep 1
    s_sub_u32 s6, s6, 1
    s_cbranch_scc0 POLL_37
PDONE_39:
    v_perm_b32 v88, v80, v83, s43
    v_perm_b32 v89, v80, v83, s44
    v_perm_b32 v90, v81, v83, s45
    v_perm_b32 v91, v81, v83, s46
    v_perm_b32 v92, v84, v87, s43
    v_perm_b32 v93, v84, v87, s44
    v_perm_b32 v94, v85, v87, s45
    v_perm_b32 v95, v85, v87, s46
    v_pk_add_f32 v[88:89], v[88:89], v[92:93]
    v_pk_add_f32 v[90:91], v[90:91], v[94:95]
    s_nop 0
    v_add_f32_dpp v88, v88, v88 row_ror:8 row_mask:0xf bank_mask:0xf
    v_add_f32_dpp v89, v89, v89 row_ror:8 row_mask:0xf bank_mask:0xf
    v_add_f32_dpp v90, v90, v90 row_ror:8 row_mask:0xf bank_mask:0xf
    v_add_f32_dpp v91, v91, v91 row_ror:8 row_mask:0xf bank_mask:0xf
    v_mov_b32 v92, v88
    v_mov_b32 v93, v89
    v_mov_b32 v94, v90
    v_mov_b32 v95, v91
    v_permlane16_swap_b32 v88, v92
    v_permlane16_swap_b32 v89, v93
    v_permlane16_swap_b32 v90, v94
    v_permlane16_swap_b32 v91, v95
    v_add_f32 v88, v88, v92
    v_add_f32 v89, v89, v93
    v_add_f32 v90, v90, v94
    v_add_f32 v91, v91, v95
    v_mov_b32 v92, v88
    v_mov_b32 v93, v89
    v_mov_b32 v94, v90
    v_mov_b32 v95, v91
    v_permlane32_swap_b32 v88, v92
    v_permlane32_swap_b32 v89, v93
    v_permlane32_swap_b32 v90, v94
    v_permlane32_swap_b32 v91, v95
    v_add_f32 v88, v88, v92
    v_add_f32 v89, v89, v93
    v_add_f32 v90, v90, v94
    v_add_f32 v91, v91, v95
    ds_write_b128 v197, v[88:91] offset:0
    s_waitcnt lgkmcnt(0)
    s_barrier
    s_cmp_lg_u32 s3, 0
    s_cbranch_scc1 SKIP_40
    ds_read_b128 v[16:19], v8 offset:0
    ds_read_b128 v[20:23], v8 offset:1024
    ds_read_b128 v[24:27], v8 offset:2048
    ds_read_b128 v[28:31], v8 offset:3072
    ds_read_b128 v[32:35], v8 offset:4096
    ds_read_b128 v[36:39], v8 offset:5120
    ds_read_b128 v[40:43], v8 offset:6144
    ds_read_b128 v[44:47], v8 offset:7168
    s_waitcnt lgkmcnt(6)
    v_pk_add_f32 v[16:17], v[16:17], v[20:21]
    v_pk_add_f32 v[18:19], v[18:19], v[22:23]
    s_waitcnt lgkmcnt(4)
    v_pk_add_f32 v[24:25], v[24:25], v[28:29]
    v_pk_add_f32 v[26:27], v[26:27], v[30:31]
    s_waitcnt lgkmcnt(2)
    v_pk_add_f32 v[32:33], v[32:33], v[36:37]
    v_pk_add_f32 v[34:35], v[34:35], v[38:39]
    s_waitcnt lgkmcnt(0)
    v_pk_add_f32 v[40:41], v[40:41], v[44:45]
    v_pk_add_f32 v[42:43], v[42:43], v[46:47]
    v_pk_add_f32 v[16:17], v[16:17], v[24:25]
    v_pk_add_f32 v[18:19], v[18:19], v[26:27]
    v_pk_add_f32 v[32:33], v[32:33], v[40:41]
    v_pk_add_f32 v[34:35], v[34:35], v[42:43]
    v_pk_add_f32 v[16:17], v[16:17], v[32:33]
    v_pk_add_f32 v[18:19], v[18:19], v[34:35]
    v_fma_f32 v16, v16, v104, v108
    v_fma_f32 v17, v17, v105, v109
    v_fma_f32 v18, v18, v106, v110
    v_fma_f32 v19, v19, v107, v111
    v_cvt_pk_bf16_f32 v16, v16, v17
    v_cvt_pk_bf16_f32 v17, v18, v19
    s_mov_b64 exec, 0xff
    buffer_store_dwordx2 v[16:17], v12, s[68:71], s16 offen
    s_mov_b64 exec, -1
    s_cmp_lg_u32 s4, 88
    s_cbranch_scc1 NOEP_41
    v_mov_b32 v14, s5
    v_mov_b32 v15, 0
    s_mov_b64 exec, 1
    buffer_store_dword v14, v15, s[48:51], 0 offen offset:0
    s_mov_b64 exec, -1
NOEP_41:
SKIP_40:
    s_branch L_DONE
L_WCU:
    s_and_b32 s9, s15, 7
    s_lshr_b32 s10, s15, 3
    s_lshl_b32 s7, s14, 1
    s_add_u32 s10, s10, s7
    s_mul_i32 s7, s9, 80
    s_lshr_b32 s8, s3, 1
    s_mul_i32 s8, s8, 20
    s_add_u32 s7, s7, s8
    s_lshl_b32 s7, s7, 13
    s_lshl_b32 s8, s10, 9
    s_add_u32 s7, s7, s8
    s_and_b32 s8, s3, 1
    s_lshl_b32 s8, s8, 8
    s_add_u32 s7, s7, s8
    v_lshlrev_b32 v12, 15, v3
    v_lshl_add_u32 v12, v2, 4, v12
    v_lshlrev_b32 v14, 13, v3
    v_lshl_add_u32 v14, v2, 4, v14
    s_mul_i32 s11, s3, 1280
    v_lshlrev_b32 v13, 2, v1
    s_mul_i32 s12, s9, 160
    s_add_u32 s12, s12, s11
    v_and_b32 v15, 31, v0
    v_min_u32 v15, 19, v15
    v_lshlrev_b32 v15, 3, v15
    s_waitcnt lgkmcnt(0)
    s_load_dword s5, s[44:45], 0
    s_mov_b32 s52, s20
    s_and_b32 s53, s21, 0xffff
    s_mov_b32 s54, 0x500000
    s_mov_b32 s55, 0x20000
    s_sleep 8
    s_add_u32 s8, s7, 0
    buffer_load_dwordx4 v[16:19], v12, s[52:55], s8 offen nt
    s_add_u32 s8, s7, 8192
    buffer_load_dwordx4 v[20:23], v12, s[52:55], s8 offen nt
    s_add_u32 s8, s7, 16384
    buffer_load_dwordx4 v[24:27], v12, s[52:55], s8 offen nt
    s_add_u32 s8, s7, 24576
    buffer_load_dwordx4 v[28:31], v12, s[52:55], s8 offen nt
    s_add_u32 s8, s7, 131072
    buffer_load_dwordx4 v[32:35], v14, s[52:55], s8 offen nt
    s_mov_b32 s56, s16
    s_and_b32 s57, s17, 0xffff
    s_mov_b32 s58, 0xa00
    s_mov_b32 s59, 0x20000
    s_cmp_ge_u32 s3, 2
    s_cbranch_scc1 SKIP_42
    buffer_load_dword v52, v13, s[56:59], s11 offen offset:0
    buffer_load_dword v53, v13, s[56:59], s11 offen offset:256
    buffer_load_dword v54, v13, s[56:59], s11 offen offset:512
    buffer_load_dword v55, v13, s[56:59], s11 offen offset:768
    buffer_load_dword v56, v13, s[56:59], s11 offen offset:1024
    buffer_load_dwordx2 v[58:59], v15, s[56:59], s12 offen
SKIP_42:
    s_mov_b32 s48, s44
    s_and_b32 s49, s45, 0xffff
    s_mov_b32 s50, 0x10000000
    s_mov_b32 s51, 0x20000
    s_mov_b32 s60, s22
    s_and_b32 s61, s23, 0xffff
    s_mov_b32 s62, 0x400000
    s_mov_b32 s63, 0x20000
    s_mov_b32 s64, s30
    s_and_b32 s65, s31, 0xffff
    s_mov_b32 s66, 0x21c000
    s_mov_b32 s67, 0x20000
    s_mov_b32 s68, s32
    s_and_b32 s69, s33, 0xffff
    s_mov_b32 s70, 0x21c000
    s_mov_b32 s71, 0x20000
    s_mov_b32 s72, s34
    s_and_b32 s73, s35, 0xffff
    s_mov_b32 s74, 0x21c000
    s_mov_b32 s75, 0x20000
    s_mov_b32 s76, s36
    s_and_b32 s77, s37, 0xffff
    s_mov_b32 s78, 0xa00
    s_mov_b32 s79, 0x20000
    s_mov_b32 s80, s38
    s_and_b32 s81, s39, 0xffff
    s_mov_b32 s82, 0x4b0000
    s_mov_b32 s83, 0x20000
    s_mov_b32 s52, s26
    s_and_b32 s53, s27, 0xffff
    s_mov_b32 s54, 0x500000
    s_mov_b32 s55, 0x20000
    s_waitcnt lgkmcnt(0)
    s_add_u32 s5, s5, 1
    s_mov_b32 s40, 0x7060302
    s_mov_b32 s41, 0xc0c0501
    s_mov_b32 s42, 0x5010c0c
    s_mov_b32 s43, 0x504000c
    s_mov_b32 s44, 0x706010c
    s_mov_b32 s45, 0x504020c
    s_mov_b32 s46, 0x706030c
    s_lshl_b32 s12, s14, 2
    s_lshr_b32 s8, s15, 2
    s_add_u32 s12, s12, s8
    s_and_b32 s13, s15, 3
    s_lshl_b32 s7, s13, 7
    s_lshl_b32 s8, s3, 4
    s_add_u32 s7, s7, s8
    s_lshl_b32 s7, s7, 13
    s_lshl_b32 s8, s12, 8
    s_add_u32 s21, s7, s8
    s_lshl_b32 s7, s3, 12
    s_add_u32 s24, s7, 16384
    v_lshlrev_b32 v12, 1, v3
    v_xor_b32 v12, v12, v2
    v_lshlrev_b32 v12, 4, v12
    v_lshl_add_u32 v200, v3, 13, v12
    v_xor_b32 v201, 0x80, v200
    v_and_b32 v12, 3, v0
    v_lshlrev_b32 v12, 1, v12
    v_and_b32 v13, 8, v0
    v_or_b32 v12, v12, v13
    v_add_u32 v13, 0, v3
    v_xor_b32 v13, v13, v12
    v_lshlrev_b32 v13, 4, v13
    v_lshl_add_u32 v13, v2, 8, v13
    v_add_u32 v202, s24, v13
    v_add_u32 v13, 4, v3
    v_xor_b32 v13, v13, v12
    v_lshlrev_b32 v13, 4, v13
    v_lshl_add_u32 v13, v2, 8, v13
    v_add_u32 v203, s24, v13
    v_add_u32 v13, 8, v3
    v_xor_b32 v13, v13, v12
    v_lshlrev_b32 v13, 4, v13
    v_lshl_add_u32 v13, v2, 8, v13
    v_add_u32 v204, s24, v13
    v_add_u32 v13, 12, v3
    v_xor_b32 v13, v13, v12
    v_lshlrev_b32 v13, 4, v13
    v_lshl_add_u32 v13, v2, 8, v13
    v_add_u32 v205, s24, v13
    v_and_b32 v12, 31, v0
    v_mul_u32_u24 v190, 5120, v11
    v_lshl_add_u32 v190, v12, 4, v190
    v_cmp_gt_u32 s[22:23], 20, v12
    s_mul_i32 s7, s3, 2560
    s_mul_i32 s8, s9, 320
    s_add_u32 s7, s7, s8
    s_add_u32 s16, s7, 40960
    s_mul_i32 s7, s3, 320
    v_add_u32 v191, s7, v8
    v_mul_u32_u24 v12, 320, v10
    s_lshr_b32 s7, s3, 1
    s_mul_i32 s7, s7, 80
    v_add_u32 v12, s7, v12
    v_lshl_add_u32 v193, v3, 2, v12
    v_lshl_add_u32 v192, v3, 4, v12
    s_lshl_b32 s7, s3, 10
    v_add_u32 v194, s7, v8
    v_lshl_add_u32 v195, v11, 9, v9
    s_lshl_b32 s7, s10, 1
    s_add_u32 s7, s7, s3
    s_lshl_b32 s7, s7, 3
    s_add_u32 s7, s7, s9
    s_lshl_b32 s7, s7, 10
    s_add_u32 s17, s7, 1048576
    s_lshl_b32 s7, s12, 13
    s_add_u32 s18, s7, 1048576
    s_add_u32 s19, s18, 4096
    v_lshlrev_b32 v196, 3, v1
    v_and_b32 v12, 1, v0
    v_lshlrev_b32 v12, 8, v12
    v_lshl_add_u32 v197, v3, 4, v12
    v_lshl_add_u32 v198, v3, 3, v12
    s_lshl_b32 s7, s3, 5
    v_add_u32 v198, s7, v198
    v_lshlrev_b32 v199, 15, v3
    v_lshl_add_u32 v199, v2, 4, v199
    s_lshl_b32 s7, s12, 2
    s_add_u32 s7, s7, s13
    s_lshl_b32 s7, s7, 8
    s_add_u32 s20, s7, 524288
    v_lshlrev_b32 v244, 15, v3
    v_lshl_add_u32 v244, v2, 4, v244
    v_lshlrev_b32 v245, 18, v10
    v_lshl_add_u32 v245, v3, 4, v245
    v_and_b32 v13, 3, v0
    v_lshl_add_u32 v245, v13, 11, v245
    s_lshl_b32 s7, s12, 13
    s_lshl_b32 s8, s13, 9
    s_add_u32 s7, s7, s8
    s_lshl_b32 s8, s3, 6
    s_add_u32 s7, s7, s8
    s_add_u32 s9, s7, 2752512
    s_mul_i32 s7, s14, 12
    s_add_u32 s7, s7, 12
    s_lshl_b32 s8, s14, 4
    s_cmp_lt_u32 s14, 3
    s_cselect_b32 s7, s8, s7
    s_add_u32 s33, s7, s15
    s_cmp_ge_u32 s15, 5
    s_cselect_b32 s12, 1, 0
    s_cselect_b32 s7, 5, 0
    s_sub_u32 s13, s15, s7
    s_lshl_b32 s7, s14, 1
    s_add_u32 s12, s12, s7
    s_lshl_b32 s7, s12, 8
    s_lshl_b32 s8, s3, 5
    s_add_u32 s7, s7, s8
    s_mul_i32 s7, s7, 1280
    s_lshl_b32 s8, s13, 8
    s_add_u32 s35, s7, s8
    v_mul_u32_u24 v218, 5120, v3
    v_lshl_add_u32 v218, v2, 4, v218
    s_mul_i32 s7, s12, 2560
    s_add_u32 s7, s7, s8
    s_add_u32 s36, s7, 589824
    s_lshl_b32 s7, s12, 1
    s_lshr_b32 s8, s3, 2
    s_add_u32 s7, s7, s8
    s_lshl_b32 s7, s7, 12
    s_and_b32 s8, s3, 3
    s_lshl_b32 s8, s8, 7
    s_add_u32 s7, s7, s8
    s_add_u32 s32, s7, 1310720
    s_and_b32 s12, s33, 3
    s_lshr_b32 s13, s33, 2
    s_mul_i32 s7, s12, 160
    s_mul_i32 s8, s3, 20
    s_add_u32 s7, s7, s8
    s_mul_i32 s7, s7, 3456
    s_lshl_b32 s8, s13, 7
    s_add_u32 s11, s7, s8
    v_and_b32 v12, 7, v0
    v_lshlrev_b32 v12, 4, v12
    s_mov_b32 s7, 0x3600
    v_mad_u32_u24 v216, v3, s7, v12
    s_mov_b32 s7, 0xd80
    v_mad_u32_u24 v217, v3, s7, v12
    v_mul_u32_u24 v12, 1280, v11
    v_lshl_add_u32 v206, v12, 1, v9
    v_lshrrev_b32 v215, 1, v206
    s_lshl_b32 s34, s3, 8
    s_lshl_b32 s7, s3, 9
    v_add_u32 v210, s7, v206
    v_bfe_u32 v14, v0, 4, 1
    v_mul_u32_u24 v14, 2560, v14
    v_add_u32 v14, v14, v12
    v_lshl_add_u32 v207, v2, 4, v14
    v_lshlrev_b32 v209, 6, v11
    s_lshl_b32 s7, s3, 3
    v_add_u32 v208, s7, v209
    v_mul_u32_u24 v12, 2560, v10
    s_mul_i32 s7, s12, 640
    s_mul_i32 s8, s3, 80
    s_add_u32 s7, s7, s8
    v_add_u32 v12, s7, v12
    v_lshl_add_u32 v211, v3, 4, v12
    v_lshl_add_u32 v212, v3, 2, v12
    v_lshlrev_b32 v214, 9, v10
    v_lshl_add_u32 v214, v3, 4, v214
    v_and_b32 v13, 3, v0
    v_lshl_add_u32 v214, v13, 10, v214
    v_bfe_u32 v13, v0, 2, 1
    s_lshl_b32 s7, s12, 6
    v_add_u32 v213, s7, v214
    v_lshl_add_u32 v213, v13, 8, v213
    v_lshl_add_u32 v214, v13, 6, v214
    s_lshl_b32 s7, s33, 10
    s_add_u32 s37, s7, 1441792
    s_lshl_b32 s7, s13, 12
    s_add_u32 s10, s7, 1441792
    s_lshl_b32 s7, s3, 9
    s_add_u32 s25, s7, 2097152
    s_add_u32 s26, s7, 2112512
    s_add_u32 s27, s7, 2107392
    s_add_u32 s29, s7, 2138112
    s_mul_i32 s8, s33, 5120
    s_add_u32 s7, s7, s8
    s_add_u32 s30, s7, 2143232
    s_add_u32 s28, s34, 589824
    s_lshl_b32 s7, s4, 12
    s_add_u32 s31, s7, 2752524
    v_cmp_eq_u32 vcc, v10, v11
    v_mov_b32 v15, 0x3f803f80
    s_nop 0
    v_cndmask_b32 v15, 0, v15, vcc
    v_and_b32 v224, v15, v4
    v_and_b32 v225, v15, v5
    v_and_b32 v226, v15, v6
    v_and_b32 v227, v15, v7
    s_cmp_lg_u32 s3, 2
    s_nop 0
    s_cbranch_scc1 SKIP_43
    v_lshlrev_b32 v124, 7, v1
    buffer_load_dword v125, v124, s[48:51], s18 offen sc1
    s_nop 0
SKIP_43:
    s_cmp_ge_u32 s3, 2
    s_cbranch_scc1 SKIP_44
    s_waitcnt vmcnt(0)
    v_lshlrev_b32 v64, 16, v52
    v_and_b32 v65, 0xffff0000, v52
    v_lshlrev_b32 v66, 16, v53
    v_and_b32 v67, 0xffff0000, v53
    v_lshlrev_b32 v68, 16, v54
    v_and_b32 v69, 0xffff0000, v54
    v_lshlrev_b32 v70, 16, v55
    v_and_b32 v71, 0xffff0000, v55
    v_lshlrev_b32 v72, 16, v56
    v_and_b32 v73, 0xffff0000, v56
    v_add_f32 v74, v64, v65
    v_add_f32 v74, v74, v66
    v_add_f32 v74, v74, v67
    v_add_f32 v74, v74, v68
    v_add_f32 v74, v74, v69
    v_add_f32 v74, v74, v70
    v_add_f32 v74, v74, v71
    v_add_f32 v74, v74, v72
    v_add_f32 v74, v74, v73
    s_nop 1
    v_add_f32_dpp v74, v74, v74 quad_perm:[1,0,3,2] row_mask:0xf bank_mask:0xf
    s_nop 1
    v_add_f32_dpp v74, v74, v74 quad_perm:[2,3,0,1] row_mask:0xf bank_mask:0xf
    s_nop 1
    v_add_f32_dpp v74, v74, v74 row_half_mirror row_mask:0xf bank_mask:0xf
    s_nop 1
    v_add_f32_dpp v74, v74, v74 row_mirror row_mask:0xf bank_mask:0xf
    v_mov_b32 v75, v74
    s_nop 1
    v_permlane16_swap_b32 v74, v75
    v_add_f32 v74, v74, v75
    v_mov_b32 v75, v74
    s_nop 1
    v_permlane32_swap_b32 v74, v75
    v_add_f32 v74, v74, v75
    v_mul_f32 v74, 0x3acccccd, v74
    v_sub_f32 v64, v64, v74
    v_sub_f32 v65, v65, v74
    v_sub_f32 v66, v66, v74
    v_sub_f32 v67, v67, v74
    v_sub_f32 v68, v68, v74
    v_sub_f32 v69, v69, v74
    v_sub_f32 v70, v70, v74
    v_sub_f32 v71, v71, v74
    v_sub_f32 v72, v72, v74
    v_sub_f32 v73, v73, v74
    v_mul_f32 v75, v64, v64
    v_fma_f32 v75, v65, v65, v75
    v_fma_f32 v75, v66, v66, v75
    v_fma_f32 v75, v67, v67, v75
    v_fma_f32 v75, v68, v68, v75
    v_fma_f32 v75, v69, v69, v75
    v_fma_f32 v75, v70, v70, v75
    v_fma_f32 v75, v71, v71, v75
    v_fma_f32 v75, v72, v72, v75
    v_fma_f32 v75, v73, v73, v75
    s_nop 1
    v_add_f32_dpp v75, v75, v75 quad_perm:[1,0,3,2] row_mask:0xf bank_mask:0xf
    s_nop 1
    v_add_f32_dpp v75, v75, v75 quad_perm:[2,3,0,1] row_mask:0xf bank_mask:0xf
    s_nop 1
    v_add_f32_dpp v75, v75, v75 row_half_mirror row_mask:0xf bank_mask:0xf
    s_nop 1
    v_add_f32_dpp v75, v75, v75 row_mirror row_mask:0xf bank_mask:0xf
    v_mov_b32 v76, v75
    s_nop 1
    v_permlane16_swap_b32 v75, v76
    v_add_f32 v75, v75, v76
    v_mov_b32 v76, v75
    s_nop 1
    v_permlane32_swap_b32 v75, v76
    v_add_f32 v75, v75, v76
    v_mul_f32 v75, 0x3acccccd, v75
    v_cvt_pk_bf16_f32 v74, v74, v74
    v_cvt_pk_bf16_f32 v75, v75, v75
    v_and_b32 v74, 0xffff0000, v74
    v_and_b32 v75, 0xffff0000, v75
    v_add_f32 v75, 0x3727c5ac, v75
    v_cvt_pk_bf16_f32 v75, v75, v75
    s_nop 0
    v_and_b32 v75, 0xffff0000, v75
    v_sqrt_f32 v75, v75
    s_nop 0
    v_cvt_pk_bf16_f32 v75, v75, v75
    s_nop 0
    v_and_b32 v75, 0xffff0000, v75
    v_rcp_f32 v75, v75
    v_lshlrev_b32 v64, 16, v58
    v_and_b32 v65, 0xffff0000, v58
    v_lshlrev_b32 v66, 16, v59
    v_and_b32 v67, 0xffff0000, v59
    v_mov_b32 v52, v64
    v_mov_b32 v53, v65
    v_mov_b32 v54, v66
    v_mov_b32 v55, v67
    v_sub_f32 v52, v52, v74
    v_sub_f32 v53, v53, v74
    v_sub_f32 v54, v54, v74
    v_sub_f32 v55, v55, v74
    v_cvt_pk_bf16_f32 v64, v52, v53
    v_cvt_pk_bf16_f32 v65, v54, v55
    v_lshlrev_b32 v52, 16, v64
    v_and_b32 v53, 0xffff0000, v64
    v_lshlrev_b32 v54, 16, v65
    v_and_b32 v55, 0xffff0000, v65
    v_mul_f32 v52, v52, v75
    v_mul_f32 v53, v53, v75
    v_mul_f32 v54, v54, v75
    v_mul_f32 v55, v55, v75
    v_cvt_pk_bf16_f32 v64, v52, v53
    v_cvt_pk_bf16_f32 v65, v54, v55
    v_lshlrev_b32 v52, 16, v64
    v_and_b32 v53, 0xffff0000, v64
    v_lshlrev_b32 v54, 16, v65
    v_and_b32 v55, 0xffff0000, v65
    s_sleep 10
    s_and_b32 s7, s15, 7
    s_mul_i32 s7, s7, 80
    s_add_u32 s8, s7, 79
    s_lshr_b32 s7, s7, 6
    s_lshr_b32 s8, s8, 6
    v_mov_b32 v105, s7
    v_mov_b32 v106, s8
    v_and_b32 v12, 1, v0
    v_cmp_eq_u32 vcc, 1, v12
    s_nop 1
    v_cndmask_b32 v105, v105, v106, vcc
    v_lshrrev_b32 v12, 1, v1
    v_mul_u32_u24 v12, 10, v12
    v_add_u32 v105, v105, v12
    v_lshlrev_b32 v105, 7, v105
    s_mov_b32 s7, 0x30000
    s_mov_b64 exec, 0xfffff
    s_mov_b32 s6, 0x186a0
POLL_45:
    buffer_load_dword v104, v105, s[48:51], s7 offen sc1
    s_waitcnt vmcnt(0)
    v_cmp_ne_u32 vcc, s5, v104
    s_nop 0
    s_nop 3
    s_cbranch_vccz PDONE_46
    s_sub_u32 s6, s6, 1
    s_cbranch_scc0 POLL_45
PDONE_46:
    s_mov_b64 exec, s[22:23]
    s_add_u32 s8, s16, 0
    buffer_load_dwordx4 v[64:67], v190, s[48:51], s8 offen sc1
    s_add_u32 s8, s16, 10240
    buffer_load_dwordx4 v[68:71], v190, s[48:51], s8 offen sc1
    s_add_u32 s8, s16, 20480
    buffer_load_dwordx4 v[72:75], v190, s[48:51], s8 offen sc1
    s_add_u32 s8, s16, 30720
    buffer_load_dwordx4 v[76:79], v190, s[48:51], s8 offen sc1
    s_add_u32 s8, s16, 40960
    buffer_load_dwordx4 v[80:83], v190, s[48:51], s8 offen sc1
    s_add_u32 s8, s16, 51200
    buffer_load_dwordx4 v[84:87], v190, s[48:51], s8 offen sc1
    s_add_u32 s8, s16, 61440
    buffer_load_dwordx4 v[88:91], v190, s[48:51], s8 offen sc1
    s_add_u32 s8, s16, 71680
    buffer_load_dwordx4 v[92:95], v190, s[48:51], s8 offen sc1
    s_add_u32 s8, s16, 81920
    buffer_load_dwordx4 v[96:99], v190, s[48:51], s8 offen sc1
    s_add_u32 s8, s16, 92160
    buffer_load_dwordx4 v[100:103], v190, s[48:51], s8 offen sc1
    s_mov_b64 exec, -1
SKIP_44:
    s_barrier
    s_cmp_lt_u32 s3, 2
    s_cbranch_scc1 SKIP_47
    s_add_u32 m0, s24, 0x0
    s_add_u32 s8, s21, 0x0
    buffer_load_dwordx4 v200, s[60:63], s8 offen nt lds
    s_add_u32 m0, s24, 0x400
    s_add_u32 s8, s21, 0x8000
    buffer_load_dwordx4 v200, s[60:63], s8 offen nt lds
    s_add_u32 m0, s24, 0x800
    s_add_u32 s8, s21, 0x10000
    buffer_load_dwordx4 v201, s[60:63], s8 offen nt lds
    s_add_u32 m0, s24, 0xc00
    s_add_u32 s8, s21, 0x18000
    buffer_load_dwordx4 v201, s[60:63], s8 offen nt lds
SKIP_47:
    s_cmp_lt_u32 s3, 6
    s_cbranch_scc1 SKIP_48
    s_add_u32 m0, s24, 0xffffa000
    s_add_u32 s8, s21, 0xfff40000
    buffer_load_dwordx4 v200, s[60:63], s8 offen nt lds
    s_add_u32 m0, s24, 0xffffa400
    s_add_u32 s8, s21, 0xfff48000
    buffer_load_dwordx4 v200, s[60:63], s8 offen nt lds
    s_add_u32 m0, s24, 0xffffa800
    s_add_u32 s8, s21, 0xfff50000
    buffer_load_dwordx4 v201, s[60:63], s8 offen nt lds
    s_add_u32 m0, s24, 0xffffac00
    s_add_u32 s8, s21, 0xfff58000
    buffer_load_dwordx4 v201, s[60:63], s8 offen nt lds
SKIP_48:
    s_cmp_ge_u32 s3, 2
    s_cbranch_scc1 SKIP_49
    s_mov_b64 exec, s[22:23]
    s_mov_b32 s6, 0x186a0
    s_branch L_E1_CHECK
L_E1_RETRY:
    s_add_u32 s8, s16, 0
    buffer_load_dwordx4 v[64:67], v190, s[48:51], s8 offen sc1
    s_add_u32 s8, s16, 10240
    buffer_load_dwordx4 v[68:71], v190, s[48:51], s8 offen sc1
    s_add_u32 s8, s16, 20480
    buffer_load_dwordx4 v[72:75], v190, s[48:51], s8 offen sc1
    s_add_u32 s8, s16, 30720
    buffer_load_dwordx4 v[76:79], v190, s[48:51], s8 offen sc1
    s_add_u32 s8, s16, 40960
    buffer_load_dwordx4 v[80:83], v190, s[48:51], s8 offen sc1
    s_add_u32 s8, s16, 51200
    buffer_load_dwordx4 v[84:87], v190, s[48:51], s8 offen sc1
    s_add_u32 s8, s16, 61440
    buffer_load_dwordx4 v[88:91], v190, s[48:51], s8 offen sc1
    s_add_u32 s8, s16, 71680
    buffer_load_dwordx4 v[92:95], v190, s[48:51], s8 offen sc1
    s_add_u32 s8, s16, 81920
    buffer_load_dwordx4 v[96:99], v190, s[48:51], s8 offen sc1
    s_add_u32 s8, s16, 92160
    buffer_load_dwordx4 v[100:103], v190, s[48:51], s8 offen sc1
L_E1_CHECK:
    s_waitcnt vmcnt(0)
    v_xor_b32 v66, s5, v66
    v_xor_b32 v70, s5, v70
    v_xor_b32 v74, s5, v74
    v_xor_b32 v78, s5, v78
    v_xor_b32 v82, s5, v82
    v_xor_b32 v86, s5, v86
    v_xor_b32 v90, s5, v90
    v_xor_b32 v94, s5, v94
    v_xor_b32 v98, s5, v98
    v_xor_b32 v102, s5, v102
    v_or3_b32 v66, v66, v70, v74
    v_or3_b32 v78, v78, v82, v86
    v_or3_b32 v90, v90, v94, v98
    v_or3_b32 v66, v66, v78, v90
    v_or_b32 v66, v66, v102
    v_cmp_ne_u32 vcc, 0, v66
    s_nop 0
    s_nop 3
    s_cbranch_vccz PDONE_50
    s_sleep 2
    s_sub_u32 s6, s6, 1
    s_cbranch_scc0 L_E1_RETRY
PDONE_50:
    s_mov_b64 exec, -1
    v_perm_b32 v108, v64, v67, s43
    v_perm_b32 v109, v64, v67, s44
    v_perm_b32 v110, v65, v67, s45
    v_perm_b32 v111, v65, v67, s46
    v_perm_b32 v112, v68, v71, s43
    v_perm_b32 v113, v68, v71, s44
    v_perm_b32 v114, v69, v71, s45
    v_perm_b32 v115, v69, v71, s46
    v_perm_b32 v116, v72, v75, s43
    v_perm_b32 v117, v72, v75, s44
    v_perm_b32 v118, v73, v75, s45
    v_perm_b32 v119, v73, v75, s46
    v_pk_add_f32 v[108:109], v[108:109], v[116:117]
    v_pk_add_f32 v[110:111], v[110:111], v[118:119]
    v_perm_b32 v120, v76, v79, s43
    v_perm_b32 v121, v76, v79, s44
    v_perm_b32 v122, v77, v79, s45
    v_perm_b32 v123, v77, v79, s46
    v_pk_add_f32 v[112:113], v[112:113], v[120:121]
    v_pk_add_f32 v[114:115], v[114:115], v[122:123]
    v_perm_b32 v116, v80, v83, s43
    v_perm_b32 v117, v80, v83, s44
    v_perm_b32 v118, v81, v83, s45
    v_perm_b32 v119, v81, v83, s46
    v_pk_add_f32 v[108:109], v[108:109], v[116:117]
    v_pk_add_f32 v[110:111], v[110:111], v[118:119]
    v_perm_b32 v120, v84, v87, s43
    v_perm_b32 v121, v84, v87, s44
    v_perm_b32 v122, v85, v87, s45
    v_perm_b32 v123, v85, v87, s46
    v_pk_add_f32 v[112:113], v[112:113], v[120:121]
    v_pk_add_f32 v[114:115], v[114:115], v[122:123]
    v_perm_b32 v116, v88, v91, s43
    v_perm_b32 v117, v88, v91, s44
    v_perm_b32 v118, v89, v91, s45
    v_perm_b32 v119, v89, v91, s46
    v_pk_add_f32 v[108:109], v[108:109], v[116:117]
    v_pk_add_f32 v[110:111], v[110:111], v[118:119]
    v_perm_b32 v120, v92, v95, s43
    v_perm_b32 v121, v92, v95, s44
    v_perm_b32 v122, v93, v95, s45
    v_perm_b32 v123, v93, v95, s46
    v_pk_add_f32 v[112:113], v[112:113], v[120:121]
    v_pk_add_f32 v[114:115], v[114:115], v[122:123]
    v_perm_b32 v116, v96, v99, s43
    v_perm_b32 v117, v96, v99, s44
    v_perm_b32 v118, v97, v99, s45
    v_perm_b32 v119, v97, v99, s46
    v_pk_add_f32 v[108:109], v[108:109], v[116:117]
    v_pk_add_f32 v[110:111], v[110:111], v[118:119]
    v_perm_b32 v120, v100, v103, s43
    v_perm_b32 v121, v100, v103, s44
    v_perm_b32 v122, v101, v103, s45
    v_perm_b32 v123, v101, v103, s46
    v_pk_add_f32 v[112:113], v[112:113], v[120:121]
    v_pk_add_f32 v[114:115], v[114:115], v[122:123]
    v_pk_add_f32 v[108:109], v[108:109], v[112:113]
    v_pk_add_f32 v[110:111], v[110:111], v[114:115]
    v_cvt_pk_bf16_f32 v116, v108, v109
    v_cvt_pk_bf16_f32 v117, v110, v111
    v_mov_b32 v118, v116
    v_mov_b32 v119, v117
    s_nop 0
    v_permlane32_swap_b32 v116, v118
    v_permlane32_swap_b32 v117, v119
    v_lshlrev_b32 v108, 16, v116
    v_and_b32 v109, 0xffff0000, v116
    v_lshlrev_b32 v110, 16, v117
    v_and_b32 v111, 0xffff0000, v117
    v_lshlrev_b32 v112, 16, v118
    v_and_b32 v113, 0xffff0000, v118
    v_lshlrev_b32 v114, 16, v119
    v_and_b32 v115, 0xffff0000, v119
    v_add_f32 v112, 1.0, v112
    v_add_f32 v113, 1.0, v113
    v_add_f32 v114, 1.0, v114
    v_add_f32 v115, 1.0, v115
    v_cvt_pk_bf16_f32 v120, v112, v113
    v_cvt_pk_bf16_f32 v121, v114, v115
    v_lshlrev_b32 v112, 16, v120
    v_and_b32 v113, 0xffff0000, v120
    v_lshlrev_b32 v114, 16, v121
    v_and_b32 v115, 0xffff0000, v121
    v_mul_f32 v112, v112, v52
    v_mul_f32 v113, v113, v53
    v_mul_f32 v114, v114, v54
    v_mul_f32 v115, v115, v55
    v_cvt_pk_bf16_f32 v120, v112, v113
    v_cvt_pk_bf16_f32 v121, v114, v115
    v_lshlrev_b32 v112, 16, v120
    v_and_b32 v113, 0xffff0000, v120
    v_lshlrev_b32 v114, 16, v121
    v_and_b32 v115, 0xffff0000, v121
    v_add_f32 v108, v108, v112
    v_add_f32 v109, v109, v113
    v_add_f32 v110, v110, v114
    v_add_f32 v111, v111, v115
    v_cvt_pk_bf16_f32 v108, v108, v108
    v_cvt_pk_bf16_f32 v109, v109, v109
    v_cvt_pk_bf16_f32 v110, v110, v110
    v_cvt_pk_bf16_f32 v111, v111, v111
    s_mov_b64 exec, 0xfffff
    ds_write_b128 v191, v[108:111] offset:0
    s_mov_b64 exec, -1
SKIP_49:
    s_waitcnt lgkmcnt(0)
    s_barrier
    ds_read_b128 v[64:67], v192 offset:0
    ds_read_b32 v68, v193 offset:64
    s_cmp_ge_u32 s3, 6
    s_cbranch_scc1 SKIP_51
    s_waitcnt vmcnt(4)
SKIP_51:
    s_waitcnt vmcnt(8)
    s_cmp_lg_u32 s3, 3
    s_cbranch_scc1 SKIP_52
    v_min_u32 v112, 49, v1
    v_lshlrev_b32 v112, 7, v112
    s_mov_b32 s7, 0x2c000
    s_mov_b32 s8, 0x2d900
    buffer_load_dword v114, v112, s[48:51], s7 offen sc1
    buffer_load_dword v115, v112, s[48:51], s8 offen sc1
SKIP_52:
    s_waitcnt lgkmcnt(0)
    v_and_b32 v76, v64, v4
    v_and_b32 v77, v64, v5
    v_and_b32 v78, v64, v6
    v_and_b32 v79, v64, v7
    v_and_b32 v80, v65, v4
    v_and_b32 v81, v65, v5
    v_and_b32 v82, v65, v6
    v_and_b32 v83, v65, v7
    v_mfma_f32_16x16x32_bf16 v[72:75], v[76:79], v[16:19], 0
    v_and_b32 v76, v66, v4
    v_and_b32 v77, v66, v5
    v_and_b32 v78, v66, v6
    v_and_b32 v79, v66, v7
    v_mfma_f32_16x16x32_bf16 v[72:75], v[80:83], v[20:23], v[72:75]
    v_and_b32 v80, v67, v4
    v_and_b32 v81, v67, v5
    v_and_b32 v82, v67, v6
    v_and_b32 v83, v67, v7
    v_mfma_f32_16x16x32_bf16 v[72:75], v[76:79], v[24:27], v[72:75]
    v_and_b32 v76, v68, v4
    v_and_b32 v77, v68, v5
    v_and_b32 v78, v68, v6
    v_and_b32 v79, v68, v7
    v_mfma_f32_16x16x32_bf16 v[72:75], v[80:83], v[28:31], v[72:75]
    s_nop 0
    v_mfma_f32_16x16x32_bf16 v[72:75], v[76:79], v[32:35], v[72:75]
    s_nop 7
    ds_write_b128 v194, v[72:75] offset:4096
    s_waitcnt lgkmcnt(0)
    s_barrier
    s_cmp_ge_u32 s3, 2
    s_cbranch_scc1 SKIP_53
    ds_read_b128 v[64:67], v194 offset:4096
    ds_read_b128 v[68:71], v194 offset:6144
    ds_read_b128 v[72:75], v194 offset:8192
    ds_read_b128 v[76:79], v194 offset:10240
    s_waitcnt lgkmcnt(2)
    v_pk_add_f32 v[64:65], v[64:65], v[68:69]
    v_pk_add_f32 v[66:67], v[66:67], v[70:71]
    s_waitcnt lgkmcnt(0)
    v_pk_add_f32 v[72:73], v[72:73], v[76:77]
    v_pk_add_f32 v[74:75], v[74:75], v[78:79]
    v_pk_add_f32 v[64:65], v[64:65], v[72:73]
    v_pk_add_f32 v[66:67], v[66:67], v[74:75]
    v_perm_b32 v80, v65, v64, s40
    v_perm_b32 v81, v67, v66, s40
    v_perm_b32 v83, v65, v64, s41
    v_perm_b32 v84, v67, v66, s42
    v_mov_b32 v82, s5
    v_or_b32 v83, v83, v84
    buffer_store_dwordx4 v[80:83], v195, s[48:51], s17 offen
    s_add_u32 s8, s17, 524288
    buffer_store_dwordx4 v[80:83], v195, s[48:51], s8 offen sc1
    s_nop 1
SKIP_53:
    s_cmp_lg_u32 s3, 2
    s_cbranch_scc1 SKIP_54
    s_sleep 3
    s_mov_b32 s6, 0x30d40
POLL_55:
    s_and_b32 s38, s6, 1
    s_cmp_gt_u32 s6, 199960
    s_cselect_b32 s38, 0, s38
    s_mul_i32 s38, s38, 524288
    s_add_u32 s7, s18, s38
    s_add_u32 s8, s19, s38
    buffer_load_dwordx4 v[64:67], v8, s[48:51], s7 offen offset:0 sc1
    buffer_load_dwordx4 v[68:71], v8, s[48:51], s7 offen offset:1024 sc1
    buffer_load_dwordx4 v[72:75], v8, s[48:51], s7 offen offset:2048 sc1
    buffer_load_dwordx4 v[76:79], v8, s[48:51], s7 offen offset:3072 sc1
    buffer_load_dwordx4 v[80:83], v8, s[48:51], s8 offen offset:0 sc1
    buffer_load_dwordx4 v[84:87], v8, s[48:51], s8 offen offset:1024 sc1
    buffer_load_dwordx4 v[88:91], v8, s[48:51], s8 offen offset:2048 sc1
    buffer_load_dwordx4 v[92:95], v8, s[48:51], s8 offen offset:3072 sc1
    s_waitcnt vmcnt(0)
    v_xor_b32 v66, s5, v66
    v_xor_b32 v70, s5, v70
    v_xor_b32 v74, s5, v74
    v_xor_b32 v78, s5, v78
    v_xor_b32 v82, s5, v82
    v_xor_b32 v86, s5, v86
    v_xor_b32 v90, s5, v90
    v_xor_b32 v94, s5, v94
    v_or3_b32 v66, v66, v70, v74
    v_or3_b32 v78, v78, v82, v86
    v_or_b32 v90, v90, v94
    v_or3_b32 v66, v66, v78, v90
    v_cmp_ne_u32 vcc, 0, v66
    s_nop 0
    s_nop 3
    s_cbranch_vccz PDONE_56
    s_sub_u32 s6, s6, 1
    s_cbranch_scc0 POLL_55
PDONE_56:
    v_perm_b32 v96, v64, v67, s43
    v_perm_b32 v97, v64, v67, s44
    v_perm_b32 v98, v65, v67, s45
    v_perm_b32 v99, v65, v67, s46
    v_perm_b32 v100, v68, v71, s43
    v_perm_b32 v101, v68, v71, s44
    v_perm_b32 v102, v69, v71, s45
    v_perm_b32 v103, v69, v71, s46
    v_perm_b32 v104, v72, v75, s43
    v_perm_b32 v105, v72, v75, s44
    v_perm_b32 v106, v73, v75, s45
    v_perm_b32 v107, v73, v75, s46
    v_pk_add_f32 v[96:97], v[96:97], v[104:105]
    v_pk_add_f32 v[98:99], v[98:99], v[106:107]
    v_perm_b32 v108, v76, v79, s43
    v_perm_b32 v109, v76, v79, s44
    v_perm_b32 v110, v77, v79, s45
    v_perm_b32 v111, v77, v79, s46
    v_pk_add_f32 v[100:101], v[100:101], v[108:109]
    v_pk_add_f32 v[102:103], v[102:103], v[110:111]
    v_perm_b32 v104, v80, v83, s43
    v_perm_b32 v105, v80, v83, s44
    v_perm_b32 v106, v81, v83, s45
    v_perm_b32 v107, v81, v83, s46
    v_pk_add_f32 v[96:97], v[96:97], v[104:105]
    v_pk_add_f32 v[98:99], v[98:99], v[106:107]
    v_perm_b32 v108, v84, v87, s43
    v_perm_b32 v109, v84, v87, s44
    v_perm_b32 v110, v85, v87, s45
    v_perm_b32 v111, v85, v87, s46
    v_pk_add_f32 v[100:101], v[100:101], v[108:109]
    v_pk_add_f32 v[102:103], v[102:103], v[110:111]
    v_perm_b32 v104, v88, v91, s43
    v_perm_b32 v105, v88, v91, s44
    v_perm_b32 v106, v89, v91, s45
    v_perm_b32 v107, v89, v91, s46
    v_pk_add_f32 v[96:97], v[96:97], v[104:105]
    v_pk_add_f32 v[98:99], v[98:99], v[106:107]
    v_perm_b32 v108, v92, v95, s43
    v_perm_b32 v109, v92, v95, s44
    v_perm_b32 v110, v93, v95, s45
    v_perm_b32 v111, v93, v95, s46
    v_pk_add_f32 v[100:101], v[100:101], v[108:109]
    v_pk_add_f32 v[102:103], v[102:103], v[110:111]
    v_pk_add_f32 v[96:97], v[96:97], v[100:101]
    v_pk_add_f32 v[98:99], v[98:99], v[102:103]
    v_cvt_pk_bf16_f32 v64, v96, v97
    v_cvt_pk_bf16_f32 v65, v98, v99
    s_nop 0
    ds_write_b64 v196, v[64:65] offset:1024
SKIP_54:
    s_cmp_lg_u32 s3, 3
    s_cbranch_scc1 SKIP_57
    s_waitcnt vmcnt(0)
    v_xor_b32 v114, s5, v114
    v_xor_b32 v115, s5, v115
    v_or_b32 v114, v114, v115
    v_cmp_ne_u32 vcc, 0, v114
    s_nop 0
    s_nop 3
    s_cbranch_vccz SKIP_57
    v_min_u32 v112, 49, v1
    v_lshlrev_b32 v112, 7, v112
    s_mov_b32 s7, 0x2c000
    s_mov_b32 s8, 0x2d900
    s_mov_b32 s6, 0x186a0
POLL_58:
    buffer_load_dword v114, v112, s[48:51], s7 offen sc1
    buffer_load_dword v115, v112, s[48:51], s8 offen sc1
    s_waitcnt vmcnt(0)
    v_xor_b32 v114, s5, v114
    v_xor_b32 v115, s5, v115
    v_or_b32 v114, v114, v115
    v_cmp_ne_u32 vcc, 0, v114
    s_nop 0
    s_nop 3
    s_cbranch_vccz PDONE_59
    s_sleep 4
    s_sub_u32 s6, s6, 1
    s_cbranch_scc0 POLL_58
PDONE_59:
SKIP_57:
    s_cmp_lt_u32 s3, 2
    s_cbranch_scc1 SKIP_60
    s_waitcnt vmcnt(0)
SKIP_60:
    s_waitcnt lgkmcnt(0)
    s_barrier
    ds_read_b128 v[36:39], v202
    ds_read_b128 v[64:67], v197 offset:1024
    ds_read_b128 v[40:43], v203
    ds_read_b128 v[68:71], v197 offset:1088
    ds_read_b128 v[44:47], v204
    ds_read_b128 v[72:75], v197 offset:1152
    ds_read_b128 v[48:51], v205
    ds_read_b128 v[76:79], v197 offset:1216
    s_waitcnt lgkmcnt(6)
    v_mfma_f32_16x16x32_bf16 v[80:83], v[36:39], v[64:67], 0
    s_waitcnt lgkmcnt(4)
    v_mfma_f32_16x16x32_bf16 v[80:83], v[40:43], v[68:71], v[80:83]
    s_waitcnt lgkmcnt(2)
    v_mfma_f32_16x16x32_bf16 v[80:83], v[44:47], v[72:75], v[80:83]
    s_waitcnt lgkmcnt(0)
    v_mfma_f32_16x16x32_bf16 v[80:83], v[48:51], v[76:79], v[80:83]
    s_mov_b32 exec_lo, 0x00030003
    s_mov_b32 exec_hi, 0x00030003
    s_nop 5
    v_cvt_pk_bf16_f32 v80, v80, v81
    v_cvt_pk_bf16_f32 v81, v82, v83
    s_nop 0
    ds_write_b64 v198, v[80:81] offset:2048
    s_mov_b64 exec, -1
    s_waitcnt lgkmcnt(0)
    s_barrier
    s_cmp_lg_u32 s3, 0
    s_cbranch_scc1 SKIP_61
    ds_read_b128 v[64:67], v8 offset:2048
    s_mov_b32 exec_hi, 0
    s_waitcnt lgkmcnt(0)
    buffer_store_dwordx4 v[64:67], v199, s[48:51], s20 offen sc1
    v_mov_b32 v68, s5
    v_mov_b32 v69, 0
    s_lshl_b32 s7, s4, 7
    s_add_u32 s7, s7, 147456
    s_mov_b64 exec, 1
    buffer_store_dword v68, v69, s[48:51], s7 offen sc1
    s_mov_b64 exec, -1
SKIP_61:
    s_load_dwordx2 s[12:13], s[0:1], 32
    s_waitcnt lgkmcnt(0)
    s_mov_b32 s60, s12
    s_and_b32 s61, s13, 0xffff
    s_sub_u32 s7, s20, 524288
    s_lshl_b32 s7, s7, 2
    s_add_u32 s22, s7, 1310720
    s_cmp_lt_u32 s14, 3
    s_cbranch_scc1 L_FFN
    s_cmp_ge_u32 s15, 12
    s_cbranch_scc1 L_MODREST
L_FFN:
    s_cmp_ge_u32 s3, 5
    s_cbranch_scc1 SKIP_62
    s_sub_u32 s7, s5, 1
    v_mov_b32 v112, s7
    v_mov_b32 v113, s7
    v_mov_b32 v114, s7
    v_mov_b32 v115, s7
    buffer_store_dwordx4 v[112:115], v206, s[48:51], s30 offen sc1
    buffer_load_dword v110, v213, s[48:51], s10 offen sc1
    s_nop 0
SKIP_62:
    s_cmp_lg_u32 s3, 1
    s_cbranch_scc1 SKIP_63
    s_lshl_b32 s7, s4, 7
    s_add_u32 s7, s7, 20480
    v_mov_b32 v145, 0
    s_mov_b64 exec, 1
    s_mov_b32 s6, 0x186a0
POLL_64:
    buffer_load_dword v144, v145, s[48:51], s7 offen sc1
    s_waitcnt vmcnt(0)
    v_cmp_ne_u32 vcc, s5, v144
    s_nop 0
    s_nop 3
    s_cbranch_vccz PDONE_65
    s_sleep 1
    s_sub_u32 s6, s6, 1
    s_cbranch_scc0 POLL_64
PDONE_65:
    s_mov_b64 exec, -1
SKIP_63:
    s_barrier
    s_mov_b32 s20, 0
    s_add_u32 s8, s21, 0
    buffer_load_dwordx4 v[228:231], v244, s[60:63], s8 offen nt
    s_add_u32 s8, s21, 8192
    buffer_load_dwordx4 v[232:235], v244, s[60:63], s8 offen nt
    s_add_u32 s8, s21, 16384
    buffer_load_dwordx4 v[236:239], v244, s[60:63], s8 offen nt
    s_add_u32 s8, s21, 24576
    buffer_load_dwordx4 v[240:243], v244, s[60:63], s8 offen nt
    s_cmp_ge_u32 s15, 10
    s_cbranch_scc1 NOWO_66
    s_add_u32 s8, s35, 0
    buffer_load_dwordx4 v[72:75], v218, s[52:55], s8 offen nt
    s_add_u32 s8, s35, 1280
    buffer_load_dwordx4 v[76:79], v218, s[52:55], s8 offen nt
    s_add_u32 s8, s35, 2560
    buffer_load_dwordx4 v[80:83], v218, s[52:55], s8 offen nt
    s_add_u32 s8, s35, 3840
    buffer_load_dwordx4 v[84:87], v218, s[52:55], s8 offen nt
    s_add_u32 s8, s35, 20480
    buffer_load_dwordx4 v[88:91], v218, s[52:55], s8 offen nt
    s_add_u32 s8, s35, 21760
    buffer_load_dwordx4 v[92:95], v218, s[52:55], s8 offen nt
    s_add_u32 s8, s35, 23040
    buffer_load_dwordx4 v[96:99], v218, s[52:55], s8 offen nt
    s_waitcnt vmcnt(6)
    s_add_u32 s8, s35, 24320
    buffer_load_dwordx4 v[100:103], v218, s[52:55], s8 offen nt
    s_branch NOWOJ_67
NOWO_66:
    s_mul_i32 s16, s14, 6
    s_lshl_b32 s7, s14, 1
    s_add_u32 s7, s7, 12
    s_cmp_lt_u32 s14, 3
    s_cselect_b32 s16, s16, s7
    s_add_u32 s16, s16, s15
    s_sub_u32 s16, s16, 10
    s_cmp_ge_u32 s16, 20
    s_cbranch_scc1 NOWOJ_67
    s_cmp_ge_u32 s16, 10
    s_cselect_b32 s17, 1, 0
    s_cselect_b32 s7, 10, 0
    s_sub_u32 s16, s16, s7
    s_mul_i32 s18, s17, 1280
    s_add_u32 s18, s18, 2560
    s_mul_i32 s19, s17, 2560
    s_sub_u32 s19, 3840, s19
    s_mul_i32 s7, s3, 16
    s_add_u32 s7, s7, 512
    v_lshl_add_u32 v12, v3, 2, s7
    v_mul_u32_u24 v13, 1280, v10
    v_lshl_add_u32 v15, v12, 1, v13
    buffer_load_dwordx2 v[88:89], v15, s[76:79], 0 offen offset:0
    v_mul_lo_u32 v13, s19, v10
    v_and_b32 v15, 7, v0
    v_lshl_add_u32 v13, v15, 4, v13
    v_mul_u32_u24 v12, 7680, v12
    v_add_u32 v12, v12, v13
    s_lshl_b32 s7, s16, 7
    s_add_u32 s7, s7, s18
    s_add_u32 s8, s7, 0
    buffer_load_dwordx4 v[72:75], v12, s[80:83], s8 offen nt
    s_add_u32 s8, s7, 7680
    buffer_load_dwordx4 v[76:79], v12, s[80:83], s8 offen nt
    s_add_u32 s8, s7, 15360
    buffer_load_dwordx4 v[80:83], v12, s[80:83], s8 offen nt
    s_add_u32 s8, s7, 23040
    buffer_load_dwordx4 v[84:87], v12, s[80:83], s8 offen nt
    s_mov_b32 s20, 1
NOWOJ_67:
    s_waitcnt vmcnt(12)
    s_add_u32 s8, s11, 0
    s_mov_b32 exec_lo, 0xff00ff
    s_mov_b32 exec_hi, 0xff00ff
    buffer_load_dwordx4 v[32:35], v216, s[64:67], s8 offen nt
    s_mov_b32 exec_lo, 0xff00ff00
    s_mov_b32 exec_hi, 0xff00ff00
    buffer_load_dwordx4 v[32:35], v216, s[68:71], s8 offen nt
    s_waitcnt vmcnt(12)
    s_add_u32 s8, s11, 3456
    s_mov_b32 exec_lo, 0xff00ff
    s_mov_b32 exec_hi, 0xff00ff
    buffer_load_dwordx4 v[36:39], v216, s[64:67], s8 offen nt
    s_mov_b32 exec_lo, 0xff00ff00
    s_mov_b32 exec_hi, 0xff00ff00
    buffer_load_dwordx4 v[36:39], v216, s[68:71], s8 offen nt
    s_waitcnt vmcnt(12)
    s_add_u32 s8, s11, 6912
    s_mov_b32 exec_lo, 0xff00ff
    s_mov_b32 exec_hi, 0xff00ff
    buffer_load_dwordx4 v[40:43], v216, s[64:67], s8 offen nt
    s_mov_b32 exec_lo, 0xff00ff00
    s_mov_b32 exec_hi, 0xff00ff00
    buffer_load_dwordx4 v[40:43], v216, s[68:71], s8 offen nt
    s_waitcnt vmcnt(12)
    s_add_u32 s8, s11, 10368
    s_mov_b32 exec_lo, 0xff00ff
    s_mov_b32 exec_hi, 0xff00ff
    buffer_load_dwordx4 v[44:47], v216, s[64:67], s8 offen nt
    s_mov_b32 exec_lo, 0xff00ff00
    s_mov_b32 exec_hi, 0xff00ff00
    buffer_load_dwordx4 v[44:47], v216, s[68:71], s8 offen nt
    s_waitcnt vmcnt(12)
    s_add_u32 s8, s11, 55296
    s_mov_b32 exec_lo, 0xff00ff
    s_mov_b32 exec_hi, 0xff00ff
    buffer_load_dwordx4 v[48:51], v217, s[64:67], s8 offen nt
    s_mov_b32 exec_lo, 0xff00ff00
    s_mov_b32 exec_hi, 0xff00ff00
    buffer_load_dwordx4 v[48:51], v217, s[68:71], s8 offen nt
    s_mov_b64 exec, -1
    s_cmp_ge_u32 s3, 5
    s_cbranch_scc1 SKIP_68
    s_mul_i32 s7, s33, 20480
    s_add_u32 s7, s7, s34
    s_waitcnt vmcnt(7)
    buffer_load_dwordx4 v[16:19], v218, s[72:75], s7 offen offset:0 nt
    s_waitcnt vmcnt(7)
    buffer_load_dwordx4 v[20:23], v218, s[72:75], s7 offen offset:1280 nt
    s_waitcnt vmcnt(7)
    buffer_load_dwordx4 v[24:27], v218, s[72:75], s7 offen offset:2560 nt
    s_waitcnt vmcnt(7)
    buffer_load_dwordx4 v[28:31], v218, s[72:75], s7 offen offset:3840 nt
    buffer_load_dwordx2 v[56:57], v215, s[56:59], s34 offen
    s_waitcnt vmcnt(0)
    v_lshlrev_b32 v52, 16, v56
    v_and_b32 v53, 0xffff0000, v56
    v_lshlrev_b32 v54, 16, v57
    v_and_b32 v55, 0xffff0000, v57
    s_nop 1
SKIP_68:
    s_cmp_eq_u32 s20, 0
    s_cbranch_scc1 NOMF_69
    s_waitcnt vmcnt(0)
    v_lshlrev_b32 v90, 16, v88
    v_and_b32 v91, 0xffff0000, v88
    v_lshlrev_b32 v92, 16, v89
    v_and_b32 v93, 0xffff0000, v89
    v_mul_f32 v94, 0x3fb8aa3b, v90
    v_mul_f32 v95, 0x3fb8aa3b, v91
    v_mul_f32 v96, 0x3fb8aa3b, v92
    v_mul_f32 v97, 0x3fb8aa3b, v93
    v_exp_f32 v94, -v94
    v_exp_f32 v95, -v95
    v_exp_f32 v96, -v96
    v_exp_f32 v97, -v97
    v_add_f32 v94, 1.0, v94
    v_add_f32 v95, 1.0, v95
    v_add_f32 v96, 1.0, v96
    v_add_f32 v97, 1.0, v97
    v_rcp_f32 v94, v94
    v_rcp_f32 v95, v95
    v_rcp_f32 v96, v96
    v_rcp_f32 v97, v97
    v_mul_f32 v90, v90, v94
    v_mul_f32 v91, v91, v95
    v_mul_f32 v92, v92, v96
    v_mul_f32 v93, v93, v97
    v_cvt_pk_bf16_f32 v90, v90, v90
    v_cvt_pk_bf16_f32 v91, v91, v91
    v_cvt_pk_bf16_f32 v92, v92, v92
    v_cvt_pk_bf16_f32 v93, v93, v93
    s_waitcnt vmcnt(0)
    v_and_b32 v104, v90, v4
    v_and_b32 v105, v90, v5
    v_and_b32 v106, v90, v6
    v_and_b32 v107, v90, v7
    v_and_b32 v108, v91, v4
    v_and_b32 v109, v91, v5
    v_and_b32 v110, v91, v6
    v_and_b32 v111, v91, v7
    v_mfma_f32_16x16x32_bf16 v[112:115], v[104:107], v[72:75], 0
    v_and_b32 v104, v92, v4
    v_and_b32 v105, v92, v5
    v_and_b32 v106, v92, v6
    v_and_b32 v107, v92, v7
    v_mfma_f32_16x16x32_bf16 v[112:115], v[108:111], v[76:79], v[112:115]
    v_and_b32 v108, v93, v4
    v_and_b32 v109, v93, v5
    v_and_b32 v110, v93, v6
    v_and_b32 v111, v93, v7
    v_mfma_f32_16x16x32_bf16 v[112:115], v[104:107], v[80:83], v[112:115]
    s_nop 0
    v_mfma_f32_16x16x32_bf16 v[112:115], v[108:111], v[84:87], v[112:115]
    s_nop 7
    ds_write_b128 v194, v[112:115] offset:49152
    s_waitcnt lgkmcnt(0)
    s_barrier
    s_cmp_lg_u32 s3, 6
    s_cbranch_scc1 SKIP_70
    ds_read_b128 v[72:75], v8 offset:49152
    ds_read_b128 v[76:79], v8 offset:50176
    ds_read_b128 v[80:83], v8 offset:51200
    ds_read_b128 v[84:87], v8 offset:52224
    ds_read_b128 v[88:91], v8 offset:53248
    ds_read_b128 v[92:95], v8 offset:54272
    ds_read_b128 v[96:99], v8 offset:55296
    ds_read_b128 v[100:103], v8 offset:56320
    s_waitcnt lgkmcnt(6)
    v_pk_add_f32 v[72:73], v[72:73], v[76:77]
    v_pk_add_f32 v[74:75], v[74:75], v[78:79]
    s_waitcnt lgkmcnt(4)
    v_pk_add_f32 v[80:81], v[80:81], v[84:85]
    v_pk_add_f32 v[82:83], v[82:83], v[86:87]
    s_waitcnt lgkmcnt(2)
    v_pk_add_f32 v[88:89], v[88:89], v[92:93]
    v_pk_add_f32 v[90:91], v[90:91], v[94:95]
    s_waitcnt lgkmcnt(0)
    v_pk_add_f32 v[96:97], v[96:97], v[100:101]
    v_pk_add_f32 v[98:99], v[98:99], v[102:103]
    v_pk_add_f32 v[72:73], v[72:73], v[80:81]
    v_pk_add_f32 v[74:75], v[74:75], v[82:83]
    v_pk_add_f32 v[88:89], v[88:89], v[96:97]
    v_pk_add_f32 v[90:91], v[90:91], v[98:99]
    v_pk_add_f32 v[72:73], v[72:73], v[88:89]
    v_pk_add_f32 v[74:75], v[74:75], v[90:91]
    v_perm_b32 v104, v73, v72, s40
    v_perm_b32 v105, v75, v74, s40
    v_perm_b32 v107, v73, v72, s41
    v_perm_b32 v108, v75, v74, s42
    v_mov_b32 v106, s5
    v_or_b32 v107, v107, v108
    v_lshl_add_u32 v12, v10, 1, v11
    v_mul_u32_u24 v12, 2560, v12
    v_and_b32 v13, 0xff, v9
    v_add_u32 v12, v12, v13
    s_mul_i32 s7, s17, 10240
    s_lshl_b32 s8, s16, 8
    s_add_u32 s7, s7, s8
    s_add_u32 s7, s7, 2117632
    buffer_store_dwordx4 v[104:107], v12, s[48:51], s7 offen sc1
    s_nop 1
SKIP_70:
NOMF_69:
    s_waitcnt vmcnt(0)
    s_cmp_lg_u32 s3, 7
    s_cbranch_scc1 SKIP_71
    v_mov_b32 v105, 0
    s_mov_b64 exec, 1
    s_mov_b32 s6, 0x186a0
POLL_72:
    buffer_load_dword v104, v105, s[48:51], s31 offen sc1
    s_waitcnt vmcnt(0)
    v_cmp_ne_u32 vcc, s5, v104
    s_nop 0
    s_nop 3
    s_cbranch_vccz PDONE_73
    s_sleep 1
    s_sub_u32 s6, s6, 1
    s_cbranch_scc0 POLL_72
PDONE_73:
    s_mov_b64 exec, -1
SKIP_71:
    s_barrier
    s_mov_b32 s6, 0x186a0
POLL_74:
    buffer_load_dwordx4 v[104:107], v245, s[48:51], s9 offen sc1
    s_waitcnt vmcnt(0)
    v_cmp_ne_u32 vcc, s5, v107
    s_nop 0
    s_nop 3
    s_cbranch_vccz PDONE_75
    s_sleep 1
    s_sub_u32 s6, s6, 1
    s_cbranch_scc0 POLL_74
PDONE_75:
    v_max_f32_dpp v128, v106, v106 quad_perm:[1,0,3,2] row_mask:0xf bank_mask:0xf
    v_lshlrev_b32 v136, 16, v104
    v_and_b32 v137, 0xffff0000, v104
    v_lshlrev_b32 v138, 16, v105
    v_and_b32 v139, 0xffff0000, v105
    v_max_f32_dpp v128, v128, v128 quad_perm:[2,3,0,1] row_mask:0xf bank_mask:0xf
    v_sub_f32 v106, v106, v128
    v_exp_f32 v140, v106
    s_nop 0
    v_mul_f32 v136, v136, v140
    v_mul_f32 v137, v137, v140
    v_mul_f32 v138, v138, v140
    v_mul_f32 v139, v139, v140
    v_add_f32_dpp v140, v140, v140 quad_perm:[1,0,3,2] row_mask:0xf bank_mask:0xf
    v_add_f32_dpp v136, v136, v136 quad_perm:[1,0,3,2] row_mask:0xf bank_mask:0xf
    v_add_f32_dpp v137, v137, v137 quad_perm:[1,0,3,2] row_mask:0xf bank_mask:0xf
    v_add_f32_dpp v138, v138, v138 quad_perm:[1,0,3,2] row_mask:0xf bank_mask:0xf
    v_add_f32_dpp v139, v139, v139 quad_perm:[1,0,3,2] row_mask:0xf bank_mask:0xf
    v_add_f32_dpp v140, v140, v140 quad_perm:[2,3,0,1] row_mask:0xf bank_mask:0xf
    v_add_f32_dpp v136, v136, v136 quad_perm:[2,3,0,1] row_mask:0xf bank_mask:0xf
    v_add_f32_dpp v137, v137, v137 quad_perm:[2,3,0,1] row_mask:0xf bank_mask:0xf
    v_add_f32_dpp v138, v138, v138 quad_perm:[2,3,0,1] row_mask:0xf bank_mask:0xf
    v_add_f32_dpp v139, v139, v139 quad_perm:[2,3,0,1] row_mask:0xf bank_mask:0xf
    v_rcp_f32 v140, v140
    s_nop 0
    v_mul_f32 v136, v136, v140
    v_mul_f32 v137, v137, v140
    v_mul_f32 v138, v138, v140
    v_mul_f32 v139, v139, v140
    v_cvt_pk_bf16_f32 v136, v136, v136
    v_cvt_pk_bf16_f32 v137, v137, v137
    v_cvt_pk_bf16_f32 v138, v138, v138
    v_cvt_pk_bf16_f32 v139, v139, v139
    v_and_b32 v120, v136, v4
    v_and_b32 v121, v136, v5
    v_and_b32 v122, v136, v6
    v_and_b32 v123, v136, v7
    v_and_b32 v124, v137, v4
    v_and_b32 v125, v137, v5
    v_and_b32 v126, v137, v6
    v_and_b32 v127, v137, v7
    v_mfma_f32_16x16x32_bf16 v[104:107], v[120:123], v[228:231], 0
    v_and_b32 v120, v138, v4
    v_and_b32 v121, v138, v5
    v_and_b32 v122, v138, v6
    v_and_b32 v123, v138, v7
    v_mfma_f32_16x16x32_bf16 v[104:107], v[124:127], v[232:235], v[104:107]
    v_and_b32 v124, v139, v4
    v_and_b32 v125, v139, v5
    v_and_b32 v126, v139, v6
    v_and_b32 v127, v139, v7
    v_mfma_f32_16x16x32_bf16 v[104:107], v[120:123], v[236:239], v[104:107]
    s_nop 0
    v_mfma_f32_16x16x32_bf16 v[104:107], v[124:127], v[240:243], v[104:107]
    s_nop 7
    ds_write_b128 v194, v[104:107] offset:57344
    s_waitcnt lgkmcnt(0)
    s_barrier
    s_cmp_lg_u32 s3, 6
    s_cbranch_scc1 SKIP_76
    ds_read_b128 v[104:107], v8 offset:57344
    ds_read_b128 v[108:111], v8 offset:58368
    ds_read_b128 v[112:115], v8 offset:59392
    ds_read_b128 v[116:119], v8 offset:60416
    ds_read_b128 v[120:123], v8 offset:61440
    ds_read_b128 v[124:127], v8 offset:62464
    ds_read_b128 v[128:131], v8 offset:63488
    ds_read_b128 v[132:135], v8 offset:64512
    s_waitcnt lgkmcnt(6)
    v_pk_add_f32 v[104:105], v[104:105], v[108:109]
    v_pk_add_f32 v[106:107], v[106:107], v[110:111]
    s_waitcnt lgkmcnt(4)
    v_pk_add_f32 v[112:113], v[112:113], v[116:117]
    v_pk_add_f32 v[114:115], v[114:115], v[118:119]
    s_waitcnt lgkmcnt(2)
    v_pk_add_f32 v[120:121], v[120:121], v[124:125]
    v_pk_add_f32 v[122:123], v[122:123], v[126:127]
    s_waitcnt lgkmcnt(0)
    v_pk_add_f32 v[128:129], v[128:129], v[132:133]
    v_pk_add_f32 v[130:131], v[130:131], v[134:135]
    v_pk_add_f32 v[104:105], v[104:105], v[112:113]
    v_pk_add_f32 v[106:107], v[106:107], v[114:115]
    v_pk_add_f32 v[120:121], v[120:121], v[128:129]
    v_pk_add_f32 v[122:123], v[122:123], v[130:131]
    v_pk_add_f32 v[104:105], v[104:105], v[120:121]
    v_pk_add_f32 v[106:107], v[106:107], v[122:123]
    v_perm_b32 v136, v105, v104, s40
    v_perm_b32 v137, v107, v106, s40
    v_perm_b32 v139, v105, v104, s41
    v_perm_b32 v140, v107, v106, s42
    v_mov_b32 v138, s5
    v_or_b32 v139, v139, v140
    buffer_store_dwordx4 v[136:139], v195, s[48:51], s22 offen
    s_add_u32 s8, s22, 524288
    buffer_store_dwordx4 v[136:139], v195, s[48:51], s8 offen sc1
    s_nop 1
SKIP_76:
    s_sleep 3
    s_mov_b32 s6, 0x30d40
POLL_77:
    s_and_b32 s38, s6, 1
    s_cmp_gt_u32 s6, 199960
    s_cselect_b32 s38, 0, s38
    s_mul_i32 s38, s38, 524288
    s_add_u32 s7, s32, s38
    buffer_load_dwordx4 v[104:107], v214, s[48:51], s7 offen offset:0 sc1
    s_waitcnt vmcnt(0)
    v_cmp_ne_u32 vcc, s5, v106
    s_nop 0
    s_nop 3
    s_cbranch_vccz PDONE_78
    s_sub_u32 s6, s6, 1
    s_cbranch_scc0 POLL_77
PDONE_78:
    s_cmp_ge_u32 s15, 10
    s_cbranch_scc1 L_W_NOWO
    v_perm_b32 v120, v104, v107, s43
    v_perm_b32 v121, v104, v107, s44
    v_perm_b32 v122, v105, v107, s45
    v_perm_b32 v123, v105, v107, s46
    v_add_f32_dpp v120, v120, v120 quad_perm:[1,0,3,2] row_mask:0xf bank_mask:0xf
    v_add_f32_dpp v121, v121, v121 quad_perm:[1,0,3,2] row_mask:0xf bank_mask:0xf
    v_add_f32_dpp v122, v122, v122 quad_perm:[1,0,3,2] row_mask:0xf bank_mask:0xf
    v_add_f32_dpp v123, v123, v123 quad_perm:[1,0,3,2] row_mask:0xf bank_mask:0xf
    v_add_f32_dpp v120, v120, v120 quad_perm:[2,3,0,1] row_mask:0xf bank_mask:0xf
    v_add_f32_dpp v121, v121, v121 quad_perm:[2,3,0,1] row_mask:0xf bank_mask:0xf
    v_add_f32_dpp v122, v122, v122 quad_perm:[2,3,0,1] row_mask:0xf bank_mask:0xf
    v_add_f32_dpp v123, v123, v123 quad_perm:[2,3,0,1] row_mask:0xf bank_mask:0xf
    v_cvt_pk_bf16_f32 v120, v120, v120
    v_cvt_pk_bf16_f32 v121, v121, v121
    v_cvt_pk_bf16_f32 v122, v122, v122
    v_cvt_pk_bf16_f32 v123, v123, v123
    v_mov_b32 v136, v120
    v_mov_b32 v144, v120
    v_mov_b32 v137, v121
    v_mov_b32 v145, v121
    v_mov_b32 v138, v122
    v_mov_b32 v146, v122
    v_mov_b32 v139, v123
    v_mov_b32 v147, v123
    v_mov_b32_dpp v136, v120 row_half_mirror row_mask:0xf bank_mask:0xa
    v_mov_b32_dpp v144, v120 row_half_mirror row_mask:0xf bank_mask:0x5
    v_mov_b32_dpp v137, v121 row_half_mirror row_mask:0xf bank_mask:0xa
    v_mov_b32_dpp v145, v121 row_half_mirror row_mask:0xf bank_mask:0x5
    v_mov_b32_dpp v138, v122 row_half_mirror row_mask:0xf bank_mask:0xa
    v_mov_b32_dpp v146, v122 row_half_mirror row_mask:0xf bank_mask:0x5
    v_mov_b32_dpp v139, v123 row_half_mirror row_mask:0xf bank_mask:0xa
    v_mov_b32_dpp v147, v123 row_half_mirror row_mask:0xf bank_mask:0x5
    v_and_b32 v108, v136, v4
    v_and_b32 v109, v136, v5
    v_and_b32 v110, v136, v6
    v_and_b32 v111, v136, v7
    v_and_b32 v112, v137, v4
    v_and_b32 v113, v137, v5
    v_and_b32 v114, v137, v6
    v_and_b32 v115, v137, v7
    v_mfma_f32_16x16x32_bf16 v[104:107], v[108:111], v[72:75], 0
    v_and_b32 v108, v138, v4
    v_and_b32 v109, v138, v5
    v_and_b32 v110, v138, v6
    v_and_b32 v111, v138, v7
    v_mfma_f32_16x16x32_bf16 v[104:107], v[112:115], v[76:79], v[104:107]
    v_and_b32 v112, v139, v4
    v_and_b32 v113, v139, v5
    v_and_b32 v114, v139, v6
    v_and_b32 v115, v139, v7
    v_mfma_f32_16x16x32_bf16 v[104:107], v[108:111], v[80:83], v[104:107]
    v_and_b32 v108, v144, v4
    v_and_b32 v109, v144, v5
    v_and_b32 v110, v144, v6
    v_and_b32 v111, v144, v7
    v_mfma_f32_16x16x32_bf16 v[104:107], v[112:115], v[84:87], v[104:107]
    v_and_b32 v112, v145, v4
    v_and_b32 v113, v145, v5
    v_and_b32 v114, v145, v6
    v_and_b32 v115, v145, v7
    v_mfma_f32_16x16x32_bf16 v[104:107], v[108:111], v[88:91], v[104:107]
    v_and_b32 v108, v146, v4
    v_and_b32 v109, v146, v5
    v_and_b32 v110, v146, v6
    v_and_b32 v111, v146, v7
    v_mfma_f32_16x16x32_bf16 v[104:107], v[112:115], v[92:95], v[104:107]
    v_and_b32 v112, v147, v4
    v_and_b32 v113, v147, v5
    v_and_b32 v114, v147, v6
    v_and_b32 v115, v147, v7
    v_mfma_f32_16x16x32_bf16 v[104:107], v[108:111], v[96:99], v[104:107]
    s_nop 0
    v_mfma_f32_16x16x32_bf16 v[104:107], v[112:115], v[100:103], v[104:107]
    s_nop 7
    ds_write_b128 v194, v[104:107] offset:8192
    s_waitcnt lgkmcnt(0)
    s_barrier
    s_cmp_lg_u32 s3, 7
    s_cbranch_scc1 SKIP_79
    ds_read_b128 v[104:107], v8 offset:8192
    ds_read_b128 v[108:111], v8 offset:9216
    ds_read_b128 v[112:115], v8 offset:10240
    ds_read_b128 v[116:119], v8 offset:11264
    ds_read_b128 v[120:123], v8 offset:12288
    ds_read_b128 v[124:127], v8 offset:13312
    ds_read_b128 v[128:131], v8 offset:14336
    ds_read_b128 v[132:135], v8 offset:15360
    s_waitcnt lgkmcnt(6)
    v_pk_add_f32 v[104:105], v[104:105], v[108:109]
    v_pk_add_f32 v[106:107], v[106:107], v[110:111]
    s_waitcnt lgkmcnt(4)
    v_pk_add_f32 v[112:113], v[112:113], v[116:117]
    v_pk_add_f32 v[114:115], v[114:115], v[118:119]
    s_waitcnt lgkmcnt(2)
    v_pk_add_f32 v[120:121], v[120:121], v[124:125]
    v_pk_add_f32 v[122:123], v[122:123], v[126:127]
    s_waitcnt lgkmcnt(0)
    v_pk_add_f32 v[128:129], v[128:129], v[132:133]
    v_pk_add_f32 v[130:131], v[130:131], v[134:135]
    v_pk_add_f32 v[104:105], v[104:105], v[112:113]
    v_pk_add_f32 v[106:107], v[106:107], v[114:115]
    v_pk_add_f32 v[120:121], v[120:121], v[128:129]
    v_pk_add_f32 v[122:123], v[122:123], v[130:131]
    v_pk_add_f32 v[104:105], v[104:105], v[120:121]
    v_pk_add_f32 v[106:107], v[106:107], v[122:123]
    v_cvt_pk_bf16_f32 v104, v104, v105
    v_cvt_pk_bf16_f32 v105, v106, v107
    s_nop 0
    buffer_store_dwordx2 v[104:105], v215, s[48:51], s36 offen sc1
    s_mul_i32 s7, s14, 10
    s_add_u32 s7, s7, s15
    s_lshl_b32 s7, s7, 7
    s_add_u32 s7, s7, 229376
    v_mov_b32 v144, 0
    v_mov_b32 v145, s5
    s_mov_b64 exec, 1
    buffer_store_dword v145, v144, s[48:51], s7 offen sc1
    s_mov_b64 exec, -1
SKIP_79:
    s_branch L_W_WOJ
L_W_NOWO:
    s_sleep 8
L_W_WOJ:
    s_cmp_ge_u32 s3, 5
    s_cbranch_scc1 SKIP_80
    s_mov_b32 s6, 0x186a0
POLL_81:
    buffer_load_dwordx4 v[104:107], v206, s[48:51], s25 offen sc1
    buffer_load_dwordx4 v[112:115], v206, s[48:51], s26 offen sc1
    buffer_load_dwordx4 v[120:123], v206, s[48:51], s27 offen sc1
    s_add_u32 s8, s25, 20480
    buffer_load_dwordx4 v[108:111], v206, s[48:51], s8 offen sc1
    s_add_u32 s8, s26, 20480
    buffer_load_dwordx4 v[116:119], v206, s[48:51], s8 offen sc1
    s_add_u32 s8, s27, 20480
    buffer_load_dwordx4 v[124:127], v206, s[48:51], s8 offen sc1
    s_waitcnt vmcnt(0)
    v_xor_b32 v106, s5, v106
    v_xor_b32 v110, s5, v110
    v_xor_b32 v114, s5, v114
    v_xor_b32 v118, s5, v118
    v_xor_b32 v122, s5, v122
    v_xor_b32 v126, s5, v126
    v_or3_b32 v106, v106, v110, v114
    v_or3_b32 v118, v118, v122, v126
    v_or_b32 v106, v106, v118
    v_cmp_ne_u32 vcc, 0, v106
    s_nop 0
    s_nop 3
    s_cbranch_vccz PDONE_82
    s_sleep 4
    s_sub_u32 s6, s6, 1
    s_cbranch_scc0 POLL_81
PDONE_82:
    v_perm_b32 v128, v104, v107, s43
    v_perm_b32 v129, v104, v107, s44
    v_perm_b32 v130, v105, v107, s45
    v_perm_b32 v131, v105, v107, s46
    v_perm_b32 v132, v108, v111, s43
    v_perm_b32 v133, v108, v111, s44
    v_perm_b32 v134, v109, v111, s45
    v_perm_b32 v135, v109, v111, s46
    v_pk_add_f32 v[128:129], v[128:129], v[132:133]
    v_pk_add_f32 v[130:131], v[130:131], v[134:135]
    v_mov_b32 v56, v128
    v_mov_b32 v57, v129
    v_mov_b32 v58, v130
    v_mov_b32 v59, v131
    v_perm_b32 v128, v112, v115, s43
    v_perm_b32 v129, v112, v115, s44
    v_perm_b32 v130, v113, v115, s45
    v_perm_b32 v131, v113, v115, s46
    v_perm_b32 v132, v116, v119, s43
    v_perm_b32 v133, v116, v119, s44
    v_perm_b32 v134, v117, v119, s45
    v_perm_b32 v135, v117, v119, s46
    v_pk_add_f32 v[128:129], v[128:129], v[132:133]
    v_pk_add_f32 v[130:131], v[130:131], v[134:135]
    v_mov_b32 v60, v128
    v_mov_b32 v61, v129
    v_mov_b32 v62, v130
    v_mov_b32 v63, v131
    v_perm_b32 v128, v120, v123, s43
    v_perm_b32 v129, v120, v123, s44
    v_perm_b32 v130, v121, v123, s45
    v_perm_b32 v131, v121, v123, s46
    v_perm_b32 v132, v124, v127, s43
    v_perm_b32 v133, v124, v127, s44
    v_perm_b32 v134, v125, v127, s45
    v_perm_b32 v135, v125, v127, s46
    v_pk_add_f32 v[128:129], v[128:129], v[132:133]
    v_pk_add_f32 v[130:131], v[130:131], v[134:135]
    v_mov_b32 v64, v128
    v_mov_b32 v65, v129
    v_mov_b32 v66, v130
    v_mov_b32 v67, v131
    v_cvt_pk_bf16_f32 v56, v56, v56
    v_cvt_pk_bf16_f32 v57, v57, v57
    v_cvt_pk_bf16_f32 v58, v58, v58
    v_cvt_pk_bf16_f32 v59, v59, v59
    v_cvt_pk_bf16_f32 v60, v60, v60
    v_cvt_pk_bf16_f32 v61, v61, v61
    v_cvt_pk_bf16_f32 v62, v62, v62
    v_cvt_pk_bf16_f32 v63, v63, v63
    v_cvt_pk_bf16_f32 v64, v64, v64
    v_cvt_pk_bf16_f32 v65, v65, v65
    v_cvt_pk_bf16_f32 v66, v66, v66
    v_cvt_pk_bf16_f32 v67, v67, v67
    v_and_b32 v56, 0xffff0000, v56
    v_and_b32 v57, 0xffff0000, v57
    v_and_b32 v58, 0xffff0000, v58
    v_and_b32 v59, 0xffff0000, v59
    v_and_b32 v60, 0xffff0000, v60
    v_and_b32 v61, 0xffff0000, v61
    v_and_b32 v62, 0xffff0000, v62
    v_and_b32 v63, 0xffff0000, v63
    v_and_b32 v64, 0xffff0000, v64
    v_and_b32 v65, 0xffff0000, v65
    v_and_b32 v66, 0xffff0000, v66
    v_and_b32 v67, 0xffff0000, v67
    v_add_f32 v60, 1.0, v60
    v_add_f32 v61, 1.0, v61
    v_add_f32 v62, 1.0, v62
    v_add_f32 v63, 1.0, v63
    v_cvt_pk_bf16_f32 v60, v60, v60
    v_cvt_pk_bf16_f32 v61, v61, v61
    v_cvt_pk_bf16_f32 v62, v62, v62
    v_cvt_pk_bf16_f32 v63, v63, v63
    v_and_b32 v60, 0xffff0000, v60
    v_and_b32 v61, 0xffff0000, v61
    v_and_b32 v62, 0xffff0000, v62
    v_and_b32 v63, 0xffff0000, v63
    s_sleep 11
    s_mov_b32 s6, 0x186a0
POLL_83:
    s_add_u32 s8, s28, 0
    buffer_load_dwordx4 v[104:107], v207, s[48:51], s8 offen sc1
    s_add_u32 s8, s28, 5120
    buffer_load_dwordx4 v[108:111], v207, s[48:51], s8 offen sc1
    s_add_u32 s8, s28, 10240
    buffer_load_dwordx4 v[112:115], v207, s[48:51], s8 offen sc1
    s_add_u32 s8, s28, 15360
    buffer_load_dwordx4 v[116:119], v207, s[48:51], s8 offen sc1
    s_add_u32 s8, s28, 20480
    buffer_load_dwordx4 v[120:123], v207, s[48:51], s8 offen sc1
    s_add_u32 s8, s28, 25600
    buffer_load_dwordx4 v[124:127], v207, s[48:51], s8 offen sc1
    s_add_u32 s8, s28, 30720
    buffer_load_dwordx4 v[128:131], v207, s[48:51], s8 offen sc1
    s_add_u32 s8, s28, 35840
    buffer_load_dwordx4 v[132:135], v207, s[48:51], s8 offen sc1
    s_waitcnt vmcnt(0)
    v_max3_u32 v136, v104, v106, v108
    v_max3_u32 v137, v105, v107, v109
    v_max3_u32 v136, v136, v110, v112
    v_max3_u32 v137, v137, v111, v113
    v_max3_u32 v136, v136, v114, v116
    v_max3_u32 v137, v137, v115, v117
    v_max3_u32 v136, v136, v118, v120
    v_max3_u32 v137, v137, v119, v121
    v_max3_u32 v136, v136, v122, v124
    v_max3_u32 v137, v137, v123, v125
    v_max3_u32 v136, v136, v126, v128
    v_max3_u32 v137, v137, v127, v129
    v_max3_u32 v136, v136, v130, v132
    v_max3_u32 v137, v137, v131, v133
    v_max_u32 v136, v136, v134
    v_max_u32 v137, v137, v135
    v_max_u32 v136, v136, v137
    v_cmp_eq_u32 vcc, -1, v136
    s_nop 0
    s_nop 3
    s_cbranch_vccz PDONE_84
    s_sleep 1
    s_sub_u32 s6, s6, 1
    s_cbranch_scc0 POLL_83
PDONE_84:
    v_mfma_f32_16x16x32_bf16 v[136:139], v[224:227], v[104:107], 0
    v_mfma_f32_16x16x32_bf16 v[136:139], v[224:227], v[108:111], v[136:139]
    v_mfma_f32_16x16x32_bf16 v[136:139], v[224:227], v[112:115], v[136:139]
    v_mfma_f32_16x16x32_bf16 v[136:139], v[224:227], v[116:119], v[136:139]
    v_mfma_f32_16x16x32_bf16 v[136:139], v[224:227], v[120:123], v[136:139]
    v_mfma_f32_16x16x32_bf16 v[136:139], v[224:227], v[124:127], v[136:139]
    v_mfma_f32_16x16x32_bf16 v[136:139], v[224:227], v[128:131], v[136:139]
    v_mfma_f32_16x16x32_bf16 v[136:139], v[224:227], v[132:135], v[136:139]
    s_nop 7
    v_fma_f32 v136, v136, v56, v52
    v_fma_f32 v137, v137, v57, v53
    v_fma_f32 v138, v138, v58, v54
    v_fma_f32 v139, v139, v59, v55
    v_cvt_pk_bf16_f32 v144, v136, v137
    v_cvt_pk_bf16_f32 v145, v138, v139
    v_lshlrev_b32 v136, 16, v144
    v_and_b32 v137, 0xffff0000, v144
    v_lshlrev_b32 v138, 16, v145
    v_and_b32 v139, 0xffff0000, v145
    v_add_f32 v104, v136, v137
    v_add_f32 v105, v138, v139
    v_add_f32 v104, v104, v105
    s_nop 1
    v_add_f32_dpp v104, v104, v104 quad_perm:[1,0,3,2] row_mask:0xf bank_mask:0xf
    s_nop 1
    v_add_f32_dpp v104, v104, v104 quad_perm:[2,3,0,1] row_mask:0xf bank_mask:0xf
    s_nop 1
    v_add_f32_dpp v104, v104, v104 row_half_mirror row_mask:0xf bank_mask:0xf
    s_nop 1
    v_add_f32_dpp v104, v104, v104 row_mirror row_mask:0xf bank_mask:0xf
    v_mov_b32 v105, v104
    s_nop 1
    v_permlane16_swap_b32 v104, v105
    v_add_f32 v104, v104, v105
    v_mul_f32 v104, 0x3c000000, v104
    v_sub_f32 v108, v136, v104
    v_sub_f32 v109, v137, v104
    v_sub_f32 v110, v138, v104
    v_sub_f32 v111, v139, v104
    v_mul_f32 v105, v108, v108
    v_mul_f32 v106, v110, v110
    v_fma_f32 v105, v109, v109, v105
    v_fma_f32 v106, v111, v111, v106
    v_add_f32 v105, v105, v106
    s_nop 1
    v_add_f32_dpp v105, v105, v105 quad_perm:[1,0,3,2] row_mask:0xf bank_mask:0xf
    s_nop 1
    v_add_f32_dpp v105, v105, v105 quad_perm:[2,3,0,1] row_mask:0xf bank_mask:0xf
    s_nop 1
    v_add_f32_dpp v105, v105, v105 row_half_mirror row_mask:0xf bank_mask:0xf
    s_nop 1
    v_add_f32_dpp v105, v105, v105 row_mirror row_mask:0xf bank_mask:0xf
    v_mov_b32 v106, v105
    s_nop 1
    v_permlane16_swap_b32 v105, v106
    v_add_f32 v105, v105, v106
    ds_write_b64 v208, v[104:105] offset:6144
    s_cmp_lg_u32 s33, 0
    s_cbranch_scc1 NOX1_85
    v_perm_b32 v148, v137, v136, s40
    v_perm_b32 v149, v139, v138, s40
    v_perm_b32 v151, v137, v136, s41
    v_perm_b32 v152, v139, v138, s42
    v_mov_b32 v150, s5
    v_or_b32 v151, v151, v152
    buffer_store_dwordx4 v[148:151], v206, s[48:51], s29 offen sc1
    s_nop 1
NOX1_85:
SKIP_80:
    s_waitcnt lgkmcnt(0)
    s_barrier
    s_cmp_ge_u32 s3, 5
    s_cbranch_scc1 SKIP_86
    ds_read_b128 v[104:107], v209 offset:6144
    ds_read_b128 v[108:111], v209 offset:6160
    ds_read_b64 v[112:113], v209 offset:6176
    s_mov_b32 s7, 0x43000000
    s_mov_b32 s8, 0x3acccccd
    v_mov_b32 v118, 0x3727c5ac
    s_waitcnt lgkmcnt(0)
    v_pk_add_f32 v[114:115], v[104:105], v[106:107]
    v_pk_add_f32 v[116:117], v[108:109], v[110:111]
    v_pk_add_f32 v[114:115], v[114:115], v[112:113]
    v_pk_add_f32 v[114:115], v[114:115], v[116:117]
    v_mul_f32 v114, 0x3e4ccccd, v114
    v_sub_f32 v104, v104, v114
    v_sub_f32 v106, v106, v114
    v_sub_f32 v108, v108, v114
    v_sub_f32 v110, v110, v114
    v_sub_f32 v112, v112, v114
    v_mul_f32 v105, v104, v104
    v_mul_f32 v107, v106, v106
    v_fma_f32 v105, v108, v108, v105
    v_fma_f32 v107, v110, v110, v107
    v_fma_f32 v105, v112, v112, v105
    v_add_f32 v105, v105, v107
    v_fma_f32 v115, v105, s7, v115
    v_fma_f32 v115, v115, s8, v118
    v_rsq_f32 v115, v115
    v_sub_f32 v136, v136, v114
    v_sub_f32 v137, v137, v114
    v_sub_f32 v138, v138, v114
    v_sub_f32 v139, v139, v114
    v_mul_f32 v104, v115, v60
    v_mul_f32 v105, v115, v61
    v_mul_f32 v106, v115, v62
    v_mul_f32 v107, v115, v63
    v_fma_f32 v136, v136, v104, v64
    v_fma_f32 v137, v137, v105, v65
    v_fma_f32 v138, v138, v106, v66
    v_fma_f32 v139, v139, v107, v67
    v_cvt_pk_bf16_f32 v136, v136, v136
    v_cvt_pk_bf16_f32 v137, v137, v137
    v_cvt_pk_bf16_f32 v138, v138, v138
    v_cvt_pk_bf16_f32 v139, v139, v139
    s_nop 0
    ds_write_b128 v210, v[136:139] offset:0
SKIP_86:
    s_waitcnt lgkmcnt(0)
    s_barrier
    ds_read_b128 v[104:107], v211 offset:0
    ds_read_b32 v108, v212 offset:64
    s_waitcnt lgkmcnt(0)
    v_and_b32 v116, v104, v4
    v_and_b32 v117, v104, v5
    v_and_b32 v118, v104, v6
    v_and_b32 v119, v104, v7
    v_and_b32 v120, v105, v4
    v_and_b32 v121, v105, v5
    v_and_b32 v122, v105, v6
    v_and_b32 v123, v105, v7
    v_mfma_f32_16x16x32_bf16 v[112:115], v[116:119], v[32:35], 0
    v_and_b32 v116, v106, v4
    v_and_b32 v117, v106, v5
    v_and_b32 v118, v106, v6
    v_and_b32 v119, v106, v7
    v_mfma_f32_16x16x32_bf16 v[112:115], v[120:123], v[36:39], v[112:115]
    v_and_b32 v120, v107, v4
    v_and_b32 v121, v107, v5
    v_and_b32 v122, v107, v6
    v_and_b32 v123, v107, v7
    v_mfma_f32_16x16x32_bf16 v[112:115], v[116:119], v[40:43], v[112:115]
    v_and_b32 v116, v108, v4
    v_and_b32 v117, v108, v5
    v_and_b32 v118, v108, v6
    v_and_b32 v119, v108, v7
    v_mfma_f32_16x16x32_bf16 v[112:115], v[120:123], v[44:47], v[112:115]
    s_nop 0
    v_mfma_f32_16x16x32_bf16 v[112:115], v[116:119], v[48:51], v[112:115]
    s_nop 7
    ds_write_b128 v194, v[112:115] offset:16384
    s_waitcnt lgkmcnt(0)
    s_barrier
    s_cmp_lg_u32 s3, 7
    s_cbranch_scc1 SKIP_87
    ds_read_b128 v[104:107], v8 offset:16384
    ds_read_b128 v[108:111], v8 offset:17408
    ds_read_b128 v[112:115], v8 offset:18432
    ds_read_b128 v[116:119], v8 offset:19456
    ds_read_b128 v[120:123], v8 offset:20480
    ds_read_b128 v[124:127], v8 offset:21504
    ds_read_b128 v[128:131], v8 offset:22528
    ds_read_b128 v[132:135], v8 offset:23552
    s_waitcnt lgkmcnt(6)
    v_pk_add_f32 v[104:105], v[104:105], v[108:109]
    v_pk_add_f32 v[106:107], v[106:107], v[110:111]
    s_waitcnt lgkmcnt(4)
    v_pk_add_f32 v[112:113], v[112:113], v[116:117]
    v_pk_add_f32 v[114:115], v[114:115], v[118:119]
    s_waitcnt lgkmcnt(2)
    v_pk_add_f32 v[120:121], v[120:121], v[124:125]
    v_pk_add_f32 v[122:123], v[122:123], v[126:127]
    s_waitcnt lgkmcnt(0)
    v_pk_add_f32 v[128:129], v[128:129], v[132:133]
    v_pk_add_f32 v[130:131], v[130:131], v[134:135]
    v_pk_add_f32 v[104:105], v[104:105], v[112:113]
    v_pk_add_f32 v[106:107], v[106:107], v[114:115]
    v_pk_add_f32 v[120:121], v[120:121], v[128:129]
    v_pk_add_f32 v[122:123], v[122:123], v[130:131]
    v_pk_add_f32 v[104:105], v[104:105], v[120:121]
    v_pk_add_f32 v[106:107], v[106:107], v[122:123]
    v_perm_b32 v136, v105, v104, s40
    v_perm_b32 v137, v107, v106, s40
    v_perm_b32 v139, v105, v104, s41
    v_perm_b32 v140, v107, v106, s42
    v_mov_b32 v138, s5
    v_or_b32 v139, v139, v140
    buffer_store_dwordx4 v[136:139], v195, s[48:51], s37 offen
    s_add_u32 s8, s37, 524288
    buffer_store_dwordx4 v[136:139], v195, s[48:51], s8 offen sc1
    s_lshl_b32 s7, s33, 7
    s_add_u32 s7, s7, 212992
    v_mov_b32 v144, 0
    s_mov_b64 exec, 1
    buffer_store_dword v138, v144, s[48:51], s7 offen sc1
    s_mov_b64 exec, -1
SKIP_87:
    s_cmp_ge_u32 s3, 5
    s_cbranch_scc1 SKIP_88
    s_sleep 3
    s_mov_b32 s6, 0x30d40
POLL_89:
    s_and_b32 s38, s6, 1
    s_cmp_gt_u32 s6, 199960
    s_cselect_b32 s38, 0, s38
    s_mul_i32 s38, s38, 524288
    s_add_u32 s7, s10, s38
    buffer_load_dwordx4 v[104:107], v213, s[48:51], s7 offen offset:0 sc1
    s_waitcnt vmcnt(0)
    v_cmp_ne_u32 vcc, s5, v106
    s_nop 0
    s_nop 3
    s_cbranch_vccz PDONE_90
    s_sub_u32 s6, s6, 1
    s_cbranch_scc0 POLL_89
PDONE_90:
    v_perm_b32 v120, v104, v107, s43
    v_perm_b32 v121, v104, v107, s44
    v_perm_b32 v122, v105, v107, s45
    v_perm_b32 v123, v105, v107, s46
    v_add_f32_dpp v120, v120, v120 quad_perm:[1,0,3,2] row_mask:0xf bank_mask:0xf
    v_add_f32_dpp v121, v121, v121 quad_perm:[1,0,3,2] row_mask:0xf bank_mask:0xf
    v_add_f32_dpp v122, v122, v122 quad_perm:[1,0,3,2] row_mask:0xf bank_mask:0xf
    v_add_f32_dpp v123, v123, v123 quad_perm:[1,0,3,2] row_mask:0xf bank_mask:0xf
    v_add_f32_dpp v120, v120, v120 quad_perm:[2,3,0,1] row_mask:0xf bank_mask:0xf
    v_add_f32_dpp v121, v121, v121 quad_perm:[2,3,0,1] row_mask:0xf bank_mask:0xf
    v_add_f32_dpp v122, v122, v122 quad_perm:[2,3,0,1] row_mask:0xf bank_mask:0xf
    v_add_f32_dpp v123, v123, v123 quad_perm:[2,3,0,1] row_mask:0xf bank_mask:0xf
    v_mov_b32 v136, v120
    v_mov_b32 v144, v120
    v_mov_b32 v137, v121
    v_mov_b32 v145, v121
    v_mov_b32 v138, v122
    v_mov_b32 v146, v122
    v_mov_b32 v139, v123
    v_mov_b32 v147, v123
    v_mov_b32_dpp v136, v120 row_half_mirror row_mask:0xf bank_mask:0xa
    v_mov_b32_dpp v144, v120 row_half_mirror row_mask:0xf bank_mask:0x5
    v_mov_b32_dpp v137, v121 row_half_mirror row_mask:0xf bank_mask:0xa
    v_mov_b32_dpp v145, v121 row_half_mirror row_mask:0xf bank_mask:0x5
    v_mov_b32_dpp v138, v122 row_half_mirror row_mask:0xf bank_mask:0xa
    v_mov_b32_dpp v146, v122 row_half_mirror row_mask:0xf bank_mask:0x5
    v_mov_b32_dpp v139, v123 row_half_mirror row_mask:0xf bank_mask:0xa
    v_mov_b32_dpp v147, v123 row_half_mirror row_mask:0xf bank_mask:0x5
    v_mul_f32 v140, 0x3fb8aa3b, v136
    v_mul_f32 v141, 0x3fb8aa3b, v137
    v_mul_f32 v142, 0x3fb8aa3b, v138
    v_mul_f32 v143, 0x3fb8aa3b, v139
    v_exp_f32 v140, -v140
    v_exp_f32 v141, -v141
    v_exp_f32 v142, -v142
    v_exp_f32 v143, -v143
    v_add_f32 v140, 1.0, v140
    v_add_f32 v141, 1.0, v141
    v_add_f32 v142, 1.0, v142
    v_add_f32 v143, 1.0, v143
    v_rcp_f32 v140, v140
    v_rcp_f32 v141, v141
    v_rcp_f32 v142, v142
    v_rcp_f32 v143, v143
    v_mul_f32 v136, v136, v140
    v_mul_f32 v137, v137, v141
    v_mul_f32 v138, v138, v142
    v_mul_f32 v139, v139, v143
    v_mul_f32 v136, v136, v144
    v_mul_f32 v137, v137, v145
    v_mul_f32 v138, v138, v146
    v_mul_f32 v139, v139, v147
    v_cvt_pk_bf16_f32 v136, v136, v136
    v_cvt_pk_bf16_f32 v137, v137, v137
    v_cvt_pk_bf16_f32 v138, v138, v138
    v_cvt_pk_bf16_f32 v139, v139, v139
    v_and_b32 v112, v136, v4
    v_and_b32 v113, v136, v5
    v_and_b32 v114, v136, v6
    v_and_b32 v115, v136, v7
    v_and_b32 v116, v137, v4
    v_and_b32 v117, v137, v5
    v_and_b32 v118, v137, v6
    v_and_b32 v119, v137, v7
    v_mfma_f32_16x16x32_bf16 v[128:131], v[112:115], v[16:19], 0
    v_and_b32 v112, v138, v4
    v_and_b32 v113, v138, v5
    v_and_b32 v114, v138, v6
    v_and_b32 v115, v138, v7
    v_mfma_f32_16x16x32_bf16 v[128:131], v[116:119], v[20:23], v[128:131]
    v_and_b32 v116, v139, v4
    v_and_b32 v117, v139, v5
    v_and_b32 v118, v139, v6
    v_and_b32 v119, v139, v7
    v_mfma_f32_16x16x32_bf16 v[128:131], v[112:115], v[24:27], v[128:131]
    s_nop 0
    v_mfma_f32_16x16x32_bf16 v[128:131], v[116:119], v[28:31], v[128:131]
    s_nop 7
    v_perm_b32 v132, v129, v128, s40
    v_perm_b32 v133, v131, v130, s40
    v_perm_b32 v135, v129, v128, s41
    v_perm_b32 v140, v131, v130, s42
    v_mov_b32 v134, s5
    v_or_b32 v135, v135, v140
    buffer_store_dwordx4 v[132:135], v206, s[48:51], s30 offen sc1
    s_nop 1
SKIP_88:
    s_branch L_DONE
L_MODREST:
    s_sub_u32 s7, s14, 3
    s_lshl_b32 s7, s7, 2
    s_add_u32 s7, s7, s15
    s_sub_u32 s16, s7, 12
    s_add_u32 s8, s21, 0
    buffer_load_dwordx4 v[228:231], v244, s[60:63], s8 offen nt
    s_add_u32 s8, s21, 8192
    buffer_load_dwordx4 v[232:235], v244, s[60:63], s8 offen nt
    s_add_u32 s8, s21, 16384
    buffer_load_dwordx4 v[236:239], v244, s[60:63], s8 offen nt
    s_add_u32 s8, s21, 24576
    buffer_load_dwordx4 v[240:243], v244, s[60:63], s8 offen nt
    s_cmp_ge_u32 s16, 10
    s_cselect_b32 s17, 1, 0
    s_cselect_b32 s7, 10, 0
    s_sub_u32 s16, s16, s7
    s_mul_i32 s18, s17, 1280
    s_add_u32 s18, s18, 2560
    s_mul_i32 s19, s17, 2560
    s_sub_u32 s19, 3840, s19
    s_mul_i32 s7, s3, 64
    s_add_u32 s7, s7, 0
    v_lshl_add_u32 v12, v3, 2, s7
    v_mul_u32_u24 v13, 1280, v10
    v_lshl_add_u32 v15, v12, 1, v13
    buffer_load_dwordx2 v[80:81], v15, s[76:79], 0 offen offset:0
    buffer_load_dwordx2 v[82:83], v15, s[76:79], 0 offen offset:32
    buffer_load_dwordx2 v[84:85], v15, s[76:79], 0 offen offset:64
    buffer_load_dwordx2 v[86:87], v15, s[76:79], 0 offen offset:96
    v_mul_lo_u32 v13, s19, v10
    v_and_b32 v15, 7, v0
    v_lshl_add_u32 v13, v15, 4, v13
    v_mul_u32_u24 v12, 7680, v12
    v_add_u32 v12, v12, v13
    s_lshl_b32 s7, s16, 7
    s_add_u32 s7, s7, s18
    s_add_u32 s8, s7, 0
    buffer_load_dwordx4 v[16:19], v12, s[80:83], s8 offen nt
    s_add_u32 s8, s7, 7680
    buffer_load_dwordx4 v[20:23], v12, s[80:83], s8 offen nt
    s_add_u32 s8, s7, 15360
    buffer_load_dwordx4 v[24:27], v12, s[80:83], s8 offen nt
    s_add_u32 s8, s7, 23040
    buffer_load_dwordx4 v[28:31], v12, s[80:83], s8 offen nt
    s_add_u32 s8, s7, 122880
    buffer_load_dwordx4 v[32:35], v12, s[80:83], s8 offen nt
    s_add_u32 s8, s7, 130560
    buffer_load_dwordx4 v[36:39], v12, s[80:83], s8 offen nt
    s_add_u32 s8, s7, 138240
    buffer_load_dwordx4 v[40:43], v12, s[80:83], s8 offen nt
    s_waitcnt vmcnt(6)
    s_add_u32 s8, s7, 145920
    buffer_load_dwordx4 v[44:47], v12, s[80:83], s8 offen nt
    s_waitcnt vmcnt(6)
    s_add_u32 s8, s7, 245760
    buffer_load_dwordx4 v[48:51], v12, s[80:83], s8 offen nt
    s_waitcnt vmcnt(6)
    s_add_u32 s8, s7, 253440
    buffer_load_dwordx4 v[52:55], v12, s[80:83], s8 offen nt
    s_waitcnt vmcnt(6)
    s_add_u32 s8, s7, 261120
    buffer_load_dwordx4 v[56:59], v12, s[80:83], s8 offen nt
    s_waitcnt vmcnt(6)
    s_add_u32 s8, s7, 268800
    buffer_load_dwordx4 v[60:63], v12, s[80:83], s8 offen nt
    s_waitcnt vmcnt(6)
    s_add_u32 s8, s7, 368640
    buffer_load_dwordx4 v[64:67], v12, s[80:83], s8 offen nt
    s_waitcnt vmcnt(6)
    s_add_u32 s8, s7, 376320
    buffer_load_dwordx4 v[68:71], v12, s[80:83], s8 offen nt
    s_waitcnt vmcnt(6)
    s_add_u32 s8, s7, 384000
    buffer_load_dwordx4 v[72:75], v12, s[80:83], s8 offen nt
    s_waitcnt vmcnt(6)
    s_add_u32 s8, s7, 391680
    buffer_load_dwordx4 v[76:79], v12, s[80:83], s8 offen nt
    s_waitcnt vmcnt(16)
    v_lshlrev_b32 v88, 16, v80
    v_and_b32 v89, 0xffff0000, v80
    v_lshlrev_b32 v90, 16, v81
    v_and_b32 v91, 0xffff0000, v81
    v_lshlrev_b32 v92, 16, v82
    v_and_b32 v93, 0xffff0000, v82
    v_lshlrev_b32 v94, 16, v83
    v_and_b32 v95, 0xffff0000, v83
    v_lshlrev_b32 v96, 16, v84
    v_and_b32 v97, 0xffff0000, v84
    v_lshlrev_b32 v98, 16, v85
    v_and_b32 v99, 0xffff0000, v85
    v_lshlrev_b32 v100, 16, v86
    v_and_b32 v101, 0xffff0000, v86
    v_lshlrev_b32 v102, 16, v87
    v_and_b32 v103, 0xffff0000, v87
    v_mul_f32 v104, 0x3fb8aa3b, v88
    v_mul_f32 v105, 0x3fb8aa3b, v89
    v_mul_f32 v106, 0x3fb8aa3b, v90
    v_mul_f32 v107, 0x3fb8aa3b, v91
    v_mul_f32 v108, 0x3fb8aa3b, v92
    v_mul_f32 v109, 0x3fb8aa3b, v93
    v_mul_f32 v110, 0x3fb8aa3b, v94
    v_mul_f32 v111, 0x3fb8aa3b, v95
    v_mul_f32 v112, 0x3fb8aa3b, v96
    v_mul_f32 v113, 0x3fb8aa3b, v97
    v_mul_f32 v114, 0x3fb8aa3b, v98
    v_mul_f32 v115, 0x3fb8aa3b, v99
    v_mul_f32 v116, 0x3fb8aa3b, v100
    v_mul_f32 v117, 0x3fb8aa3b, v101
    v_mul_f32 v118, 0x3fb8aa3b, v102
    v_mul_f32 v119, 0x3fb8aa3b, v103
    v_exp_f32 v104, -v104
    v_exp_f32 v105, -v105
    v_exp_f32 v106, -v106
    v_exp_f32 v107, -v107
    v_exp_f32 v108, -v108
    v_exp_f32 v109, -v109
    v_exp_f32 v110, -v110
    v_exp_f32 v111, -v111
    v_exp_f32 v112, -v112
    v_exp_f32 v113, -v113
    v_exp_f32 v114, -v114
    v_exp_f32 v115, -v115
    v_exp_f32 v116, -v116
    v_exp_f32 v117, -v117
    v_exp_f32 v118, -v118
    v_exp_f32 v119, -v119
    v_add_f32 v104, 1.0, v104
    v_add_f32 v105, 1.0, v105
    v_add_f32 v106, 1.0, v106
    v_add_f32 v107, 1.0, v107
    v_add_f32 v108, 1.0, v108
    v_add_f32 v109, 1.0, v109
    v_add_f32 v110, 1.0, v110
    v_add_f32 v111, 1.0, v111
    v_add_f32 v112, 1.0, v112
    v_add_f32 v113, 1.0, v113
    v_add_f32 v114, 1.0, v114
    v_add_f32 v115, 1.0, v115
    v_add_f32 v116, 1.0, v116
    v_add_f32 v117, 1.0, v117
    v_add_f32 v118, 1.0, v118
    v_add_f32 v119, 1.0, v119
    v_rcp_f32 v104, v104
    v_rcp_f32 v105, v105
    v_rcp_f32 v106, v106
    v_rcp_f32 v107, v107
    v_rcp_f32 v108, v108
    v_rcp_f32 v109, v109
    v_rcp_f32 v110, v110
    v_rcp_f32 v111, v111
    v_rcp_f32 v112, v112
    v_rcp_f32 v113, v113
    v_rcp_f32 v114, v114
    v_rcp_f32 v115, v115
    v_rcp_f32 v116, v116
    v_rcp_f32 v117, v117
    v_rcp_f32 v118, v118
    v_rcp_f32 v119, v119
    v_mul_f32 v88, v88, v104
    v_mul_f32 v89, v89, v105
    v_mul_f32 v90, v90, v106
    v_mul_f32 v91, v91, v107
    v_mul_f32 v92, v92, v108
    v_mul_f32 v93, v93, v109
    v_mul_f32 v94, v94, v110
    v_mul_f32 v95, v95, v111
    v_mul_f32 v96, v96, v112
    v_mul_f32 v97, v97, v113
    v_mul_f32 v98, v98, v114
    v_mul_f32 v99, v99, v115
    v_mul_f32 v100, v100, v116
    v_mul_f32 v101, v101, v117
    v_mul_f32 v102, v102, v118
    v_mul_f32 v103, v103, v119
    v_cvt_pk_bf16_f32 v88, v88, v88
    v_cvt_pk_bf16_f32 v89, v89, v89
    v_cvt_pk_bf16_f32 v90, v90, v90
    v_cvt_pk_bf16_f32 v91, v91, v91
    v_cvt_pk_bf16_f32 v92, v92, v92
    v_cvt_pk_bf16_f32 v93, v93, v93
    v_cvt_pk_bf16_f32 v94, v94, v94
    v_cvt_pk_bf16_f32 v95, v95, v95
    v_cvt_pk_bf16_f32 v96, v96, v96
    v_cvt_pk_bf16_f32 v97, v97, v97
    v_cvt_pk_bf16_f32 v98, v98, v98
    v_cvt_pk_bf16_f32 v99, v99, v99
    v_cvt_pk_bf16_f32 v100, v100, v100
    v_cvt_pk_bf16_f32 v101, v101, v101
    v_cvt_pk_bf16_f32 v102, v102, v102
    v_cvt_pk_bf16_f32 v103, v103, v103
    s_waitcnt vmcnt(0)
    v_and_b32 v104, v88, v4
    v_and_b32 v105, v88, v5
    v_and_b32 v106, v88, v6
    v_and_b32 v107, v88, v7
    v_and_b32 v108, v89, v4
    v_and_b32 v109, v89, v5
    v_and_b32 v110, v89, v6
    v_and_b32 v111, v89, v7
    v_mfma_f32_16x16x32_bf16 v[112:115], v[104:107], v[16:19], 0
    v_and_b32 v104, v90, v4
    v_and_b32 v105, v90, v5
    v_and_b32 v106, v90, v6
    v_and_b32 v107, v90, v7
    v_mfma_f32_16x16x32_bf16 v[112:115], v[108:111], v[20:23], v[112:115]
    v_and_b32 v108, v91, v4
    v_and_b32 v109, v91, v5
    v_and_b32 v110, v91, v6
    v_and_b32 v111, v91, v7
    v_mfma_f32_16x16x32_bf16 v[112:115], v[104:107], v[24:27], v[112:115]
    v_and_b32 v104, v92, v4
    v_and_b32 v105, v92, v5
    v_and_b32 v106, v92, v6
    v_and_b32 v107, v92, v7
    v_mfma_f32_16x16x32_bf16 v[112:115], v[108:111], v[28:31], v[112:115]
    v_and_b32 v108, v93, v4
    v_and_b32 v109, v93, v5
    v_and_b32 v110, v93, v6
    v_and_b32 v111, v93, v7
    v_mfma_f32_16x16x32_bf16 v[112:115], v[104:107], v[32:35], v[112:115]
    v_and_b32 v104, v94, v4
    v_and_b32 v105, v94, v5
    v_and_b32 v106, v94, v6
    v_and_b32 v107, v94, v7
    v_mfma_f32_16x16x32_bf16 v[112:115], v[108:111], v[36:39], v[112:115]
    v_and_b32 v108, v95, v4
    v_and_b32 v109, v95, v5
    v_and_b32 v110, v95, v6
    v_and_b32 v111, v95, v7
    v_mfma_f32_16x16x32_bf16 v[112:115], v[104:107], v[40:43], v[112:115]
    v_and_b32 v104, v96, v4
    v_and_b32 v105, v96, v5
    v_and_b32 v106, v96, v6
    v_and_b32 v107, v96, v7
    v_mfma_f32_16x16x32_bf16 v[112:115], v[108:111], v[44:47], v[112:115]
    v_and_b32 v108, v97, v4
    v_and_b32 v109, v97, v5
    v_and_b32 v110, v97, v6
    v_and_b32 v111, v97, v7
    v_mfma_f32_16x16x32_bf16 v[112:115], v[104:107], v[48:51], v[112:115]
    v_and_b32 v104, v98, v4
    v_and_b32 v105, v98, v5
    v_and_b32 v106, v98, v6
    v_and_b32 v107, v98, v7
    v_mfma_f32_16x16x32_bf16 v[112:115], v[108:111], v[52:55], v[112:115]
    v_and_b32 v108, v99, v4
    v_and_b32 v109, v99, v5
    v_and_b32 v110, v99, v6
    v_and_b32 v111, v99, v7
    v_mfma_f32_16x16x32_bf16 v[112:115], v[104:107], v[56:59], v[112:115]
    v_and_b32 v104, v100, v4
    v_and_b32 v105, v100, v5
    v_and_b32 v106, v100, v6
    v_and_b32 v107, v100, v7
    v_mfma_f32_16x16x32_bf16 v[112:115], v[108:111], v[60:63], v[112:115]
    v_and_b32 v108, v101, v4
    v_and_b32 v109, v101, v5
    v_and_b32 v110, v101, v6
    v_and_b32 v111, v101, v7
    v_mfma_f32_16x16x32_bf16 v[112:115], v[104:107], v[64:67], v[112:115]
    v_and_b32 v104, v102, v4
    v_and_b32 v105, v102, v5
    v_and_b32 v106, v102, v6
    v_and_b32 v107, v102, v7
    v_mfma_f32_16x16x32_bf16 v[112:115], v[108:111], v[68:71], v[112:115]
    v_and_b32 v108, v103, v4
    v_and_b32 v109, v103, v5
    v_and_b32 v110, v103, v6
    v_and_b32 v111, v103, v7
    v_mfma_f32_16x16x32_bf16 v[112:115], v[104:107], v[72:75], v[112:115]
    s_nop 0
    v_mfma_f32_16x16x32_bf16 v[112:115], v[108:111], v[76:79], v[112:115]
    s_nop 7
    ds_write_b128 v194, v[112:115] offset:49152
    s_waitcnt lgkmcnt(0)
    s_barrier
    s_cmp_lg_u32 s3, 6
    s_cbranch_scc1 SKIP_91
    ds_read_b128 v[16:19], v8 offset:49152
    ds_read_b128 v[20:23], v8 offset:50176
    ds_read_b128 v[24:27], v8 offset:51200
    ds_read_b128 v[28:31], v8 offset:52224
    ds_read_b128 v[32:35], v8 offset:53248
    ds_read_b128 v[36:39], v8 offset:54272
    ds_read_b128 v[40:43], v8 offset:55296
    ds_read_b128 v[44:47], v8 offset:56320
    s_waitcnt lgkmcnt(6)
    v_pk_add_f32 v[16:17], v[16:17], v[20:21]
    v_pk_add_f32 v[18:19], v[18:19], v[22:23]
    s_waitcnt lgkmcnt(4)
    v_pk_add_f32 v[24:25], v[24:25], v[28:29]
    v_pk_add_f32 v[26:27], v[26:27], v[30:31]
    s_waitcnt lgkmcnt(2)
    v_pk_add_f32 v[32:33], v[32:33], v[36:37]
    v_pk_add_f32 v[34:35], v[34:35], v[38:39]
    s_waitcnt lgkmcnt(0)
    v_pk_add_f32 v[40:41], v[40:41], v[44:45]
    v_pk_add_f32 v[42:43], v[42:43], v[46:47]
    v_pk_add_f32 v[16:17], v[16:17], v[24:25]
    v_pk_add_f32 v[18:19], v[18:19], v[26:27]
    v_pk_add_f32 v[32:33], v[32:33], v[40:41]
    v_pk_add_f32 v[34:35], v[34:35], v[42:43]
    v_pk_add_f32 v[16:17], v[16:17], v[32:33]
    v_pk_add_f32 v[18:19], v[18:19], v[34:35]
    v_perm_b32 v104, v17, v16, s40
    v_perm_b32 v105, v19, v18, s40
    v_perm_b32 v107, v17, v16, s41
    v_perm_b32 v108, v19, v18, s42
    v_mov_b32 v106, s5
    v_or_b32 v107, v107, v108
    v_lshl_add_u32 v12, v10, 1, v11
    v_mul_u32_u24 v12, 2560, v12
    v_and_b32 v13, 0xff, v9
    v_add_u32 v12, v12, v13
    s_mul_i32 s7, s17, 10240
    s_lshl_b32 s8, s16, 8
    s_add_u32 s7, s7, s8
    s_add_u32 s7, s7, 2097152
    buffer_store_dwordx4 v[104:107], v12, s[48:51], s7 offen sc1
    s_nop 1
SKIP_91:
    s_cmp_lg_u32 s3, 7
    s_cbranch_scc1 SKIP_92
    v_mov_b32 v141, 0
    s_mov_b64 exec, 1
    s_mov_b32 s6, 0x186a0
POLL_93:
    buffer_load_dword v140, v141, s[48:51], s31 offen sc1
    s_waitcnt vmcnt(0)
    v_cmp_ne_u32 vcc, s5, v140
    s_nop 0
    s_nop 3
    s_cbranch_vccz PDONE_94
    s_sleep 1
    s_sub_u32 s6, s6, 1
    s_cbranch_scc0 POLL_93
PDONE_94:
    s_mov_b64 exec, -1
SKIP_92:
    s_barrier
    s_mov_b32 s6, 0x186a0
POLL_95:
    buffer_load_dwordx4 v[140:143], v245, s[48:51], s9 offen sc1
    s_waitcnt vmcnt(0)
    v_cmp_ne_u32 vcc, s5, v143
    s_nop 0
    s_nop 3
    s_cbranch_vccz PDONE_96
    s_sleep 1
    s_sub_u32 s6, s6, 1
    s_cbranch_scc0 POLL_95
PDONE_96:
    v_max_f32_dpp v164, v142, v142 quad_perm:[1,0,3,2] row_mask:0xf bank_mask:0xf
    v_lshlrev_b32 v172, 16, v140
    v_and_b32 v173, 0xffff0000, v140
    v_lshlrev_b32 v174, 16, v141
    v_and_b32 v175, 0xffff0000, v141
    v_max_f32_dpp v164, v164, v164 quad_perm:[2,3,0,1] row_mask:0xf bank_mask:0xf
    v_sub_f32 v142, v142, v164
    v_exp_f32 v176, v142
    s_nop 0
    v_mul_f32 v172, v172, v176
    v_mul_f32 v173, v173, v176
    v_mul_f32 v174, v174, v176
    v_mul_f32 v175, v175, v176
    v_add_f32_dpp v176, v176, v176 quad_perm:[1,0,3,2] row_mask:0xf bank_mask:0xf
    v_add_f32_dpp v172, v172, v172 quad_perm:[1,0,3,2] row_mask:0xf bank_mask:0xf
    v_add_f32_dpp v173, v173, v173 quad_perm:[1,0,3,2] row_mask:0xf bank_mask:0xf
    v_add_f32_dpp v174, v174, v174 quad_perm:[1,0,3,2] row_mask:0xf bank_mask:0xf
    v_add_f32_dpp v175, v175, v175 quad_perm:[1,0,3,2] row_mask:0xf bank_mask:0xf
    v_add_f32_dpp v176, v176, v176 quad_perm:[2,3,0,1] row_mask:0xf bank_mask:0xf
    v_add_f32_dpp v172, v172, v172 quad_perm:[2,3,0,1] row_mask:0xf bank_mask:0xf
    v_add_f32_dpp v173, v173, v173 quad_perm:[2,3,0,1] row_mask:0xf bank_mask:0xf
    v_add_f32_dpp v174, v174, v174 quad_perm:[2,3,0,1] row_mask:0xf bank_mask:0xf
    v_add_f32_dpp v175, v175, v175 quad_perm:[2,3,0,1] row_mask:0xf bank_mask:0xf
    v_rcp_f32 v176, v176
    s_nop 0
    v_mul_f32 v172, v172, v176
    v_mul_f32 v173, v173, v176
    v_mul_f32 v174, v174, v176
    v_mul_f32 v175, v175, v176
    v_cvt_pk_bf16_f32 v172, v172, v172
    v_cvt_pk_bf16_f32 v173, v173, v173
    v_cvt_pk_bf16_f32 v174, v174, v174
    v_cvt_pk_bf16_f32 v175, v175, v175
    v_and_b32 v156, v172, v4
    v_and_b32 v157, v172, v5
    v_and_b32 v158, v172, v6
    v_and_b32 v159, v172, v7
    v_and_b32 v160, v173, v4
    v_and_b32 v161, v173, v5
    v_and_b32 v162, v173, v6
    v_and_b32 v163, v173, v7
    v_mfma_f32_16x16x32_bf16 v[140:143], v[156:159], v[228:231], 0
    v_and_b32 v156, v174, v4
    v_and_b32 v157, v174, v5
    v_and_b32 v158, v174, v6
    v_and_b32 v159, v174, v7
    v_mfma_f32_16x16x32_bf16 v[140:143], v[160:163], v[232:235], v[140:143]
    v_and_b32 v160, v175, v4
    v_and_b32 v161, v175, v5
    v_and_b32 v162, v175, v6
    v_and_b32 v163, v175, v7
    v_mfma_f32_16x16x32_bf16 v[140:143], v[156:159], v[236:239], v[140:143]
    s_nop 0
    v_mfma_f32_16x16x32_bf16 v[140:143], v[160:163], v[240:243], v[140:143]
    s_nop 7
    ds_write_b128 v194, v[140:143] offset:57344
    s_waitcnt lgkmcnt(0)
    s_barrier
    s_cmp_lg_u32 s3, 6
    s_cbranch_scc1 SKIP_97
    ds_read_b128 v[140:143], v8 offset:57344
    ds_read_b128 v[144:147], v8 offset:58368
    ds_read_b128 v[148:151], v8 offset:59392
    ds_read_b128 v[152:155], v8 offset:60416
    ds_read_b128 v[156:159], v8 offset:61440
    ds_read_b128 v[160:163], v8 offset:62464
    ds_read_b128 v[164:167], v8 offset:63488
    ds_read_b128 v[168:171], v8 offset:64512
    s_waitcnt lgkmcnt(6)
    v_pk_add_f32 v[140:141], v[140:141], v[144:145]
    v_pk_add_f32 v[142:143], v[142:143], v[146:147]
    s_waitcnt lgkmcnt(4)
    v_pk_add_f32 v[148:149], v[148:149], v[152:153]
    v_pk_add_f32 v[150:151], v[150:151], v[154:155]
    s_waitcnt lgkmcnt(2)
    v_pk_add_f32 v[156:157], v[156:157], v[160:161]
    v_pk_add_f32 v[158:159], v[158:159], v[162:163]
    s_waitcnt lgkmcnt(0)
    v_pk_add_f32 v[164:165], v[164:165], v[168:169]
    v_pk_add_f32 v[166:167], v[166:167], v[170:171]
    v_pk_add_f32 v[140:141], v[140:141], v[148:149]
    v_pk_add_f32 v[142:143], v[142:143], v[150:151]
    v_pk_add_f32 v[156:157], v[156:157], v[164:165]
    v_pk_add_f32 v[158:159], v[158:159], v[166:167]
    v_pk_add_f32 v[140:141], v[140:141], v[156:157]
    v_pk_add_f32 v[142:143], v[142:143], v[158:159]
    v_perm_b32 v172, v141, v140, s40
    v_perm_b32 v173, v143, v142, s40
    v_perm_b32 v175, v141, v140, s41
    v_perm_b32 v176, v143, v142, s42
    v_mov_b32 v174, s5
    v_or_b32 v175, v175, v176
    buffer_store_dwordx4 v[172:175], v195, s[48:51], s22 offen
    s_add_u32 s8, s22, 524288
    buffer_store_dwordx4 v[172:175], v195, s[48:51], s8 offen sc1
    s_nop 1
SKIP_97:
L_DONE:
L_END:
    s_endpgm
L_CODE_END:
.section .rodata,"a"
.p2align 6
.amdhsa_kernel adaLN_cond__compressed_kv_cla__swiglu_ffn__decode_kernel
  .amdhsa_next_free_vgpr 256
  .amdhsa_next_free_sgpr 102
  .amdhsa_accum_offset 256
  .amdhsa_group_segment_fixed_size 0
  .amdhsa_kernarg_size 120
  .amdhsa_user_sgpr_count 2
  .amdhsa_user_sgpr_kernarg_segment_ptr 1
  .amdhsa_system_sgpr_workgroup_id_x 1
.end_amdhsa_kernel
```
